```python
import torch

def _softmax(x, axis=-1):
    return torch.softmax(x, dim=axis)
def _gelu(x):
    return torch.nn.functional.gelu(x, approximate="tanh")
def _silu(x):
    return torch.nn.functional.silu(x)
def _sigmoid(x):
    return torch.sigmoid(x)
def _layernorm(x, axis=-1, eps=1e-5):
    m = x.mean(dim=axis, keepdim=True)
    v = x.var(dim=axis, keepdim=True, unbiased=False)
    return (x - m) / torch.sqrt(v + eps)
def _scatter_add(tgt, idx, src, axis=0):
    return tgt.clone().index_add_(axis, idx, src)
def _segment_sum(src, seg, n):
    out = torch.zeros((n,) + src.shape[1:], dtype=src.dtype)
    return out.index_add_(0, seg, src)
def _pad(x, pw):
    flat = tuple(v for pair in reversed(pw) for v in pair)
    return torch.nn.functional.pad(x, flat)

kernel_name = 'recurrent_scan__mha_block_cached__dense_activation_squared_relu__decode'

def setup_inputs():

    _w = (lambda a: (lambda t: t.to(torch.bfloat16) if t.is_floating_point() else t)(torch.as_tensor(a)))
    def _A_setup():
        B, Sq, D = 8, 1, 640
        H, Sk, Dh = 32, 4096, 192
        return {
            "x": _w((lambda *s: torch.randn(*s, dtype=torch.bfloat16) * 0.05)(B, Sq, D)),
            "k_cache": _w((lambda *s: torch.randn(*s, dtype=torch.bfloat16) * 0.8)(B, H, Sk, Dh)),
            "v_cache": _w((lambda *s: torch.randn(*s, dtype=torch.bfloat16) * 0.2)(B, H, Sk, Dh)),
            "wq": _w((lambda *s: torch.randn(*s, dtype=torch.bfloat16) * 0.8)(D, H * Dh) * (D ** -0.5)),
            "wo": _w((lambda *s: torch.randn(*s, dtype=torch.bfloat16) * 0.2)(H * Dh, D) * ((H * Dh) ** -0.5)),
        }
    _A_in = _A_setup()

    def _B_setup():
        B, S, D, F = 8, 1, 640, 1536
        return {
            "x": _w((lambda *s: torch.randn(*s, dtype=torch.bfloat16) * 0.05)(B, S, D)),
            "w1": _w((lambda *s: torch.randn(*s, dtype=torch.bfloat16) * 0.1)(D, F)),
            "b1": _w((lambda *s: torch.randn(*s, dtype=torch.bfloat16) * 0.1)(F)),
            "w2": _w((lambda *s: torch.randn(*s, dtype=torch.bfloat16) * 0.1)(F, D)),
            "b2": _w((lambda *s: torch.randn(*s, dtype=torch.bfloat16) * 0.1)(D)),
        }
    _B_in = _B_setup()

    return {
        "A_x": _A_in["x"],
        "A_k_cache": _A_in["k_cache"],
        "A_v_cache": _A_in["v_cache"],
        "A_wq": _A_in["wq"],
        "A_wo": _A_in["wo"],
        "B_x": _B_in["x"],
        "B_w1": _B_in["w1"],
        "B_b1": _B_in["b1"],
        "B_w2": _B_in["w2"],
        "B_b2": _B_in["b2"],
    }

def reference(A_x, A_k_cache, A_v_cache, A_wq, A_wo, B_x, B_w1, B_b1, B_w2, B_b2):
    def _A_ref(x, k_cache, v_cache, wq, wo):
        B, Sq, D = x.shape
        H, Dh = 32, 192
        q = (lambda x, *d: x.permute(*d))((x @ wq).reshape(B, Sq, H, Dh), 0, 2, 1, 3)
        scores = torch.einsum("bhqd,bhkd->bhqk", q, k_cache) * (Dh ** -0.5)
        p = _softmax(scores, axis=-1)
        o = torch.einsum("bhqk,bhkd->bhqd", p, v_cache)
        return (lambda x, *d: x.permute(*d))(o, 0, 2, 1, 3).reshape(B, Sq, H * Dh) @ wo

    def _B_ref(x, w1, b1, w2, b2):
        h = torch.einsum("bsd,df->bsf", x, w1) + b1
        zero = torch.zeros_like(h)
        r = torch.where(h > zero, h, zero)
        h = r * r
        out = torch.einsum("bsf,fd->bsd", h, w2) + b2
        return out

    x = A_x
    xn = _layernorm(x, axis=-1)
    s = _A_ref(xn, A_k_cache, A_v_cache, A_wq, A_wo)
    g = _silu(_B_ref(xn, B_w1, B_b1, B_w2, B_b2))
    return x + s * g
```

```asm
; @launch kernel=recurrent_scan__mha_block_cached__dense_activation_squared_relu__decode_kernel grid=(256,1,1) block=(512,1,1) lds=90112
; @launch kernel=final_reduce_kernel grid=(320,1,1) block=(64,1,1) lds=0
.amdgcn_target "amdgcn-amd-amdhsa--gfx950"
.text
.globl recurrent_scan__mha_block_cached__dense_activation_squared_relu__decode_kernel
.p2align 8
.type recurrent_scan__mha_block_cached__dense_activation_squared_relu__decode_kernel,@function
recurrent_scan__mha_block_cached__dense_activation_squared_relu__decode_kernel:

  s_cmp_ge_u32 s2, 256
  s_cbranch_scc1 recurrent_scan__mha_block_cached__dense_activation_squared_relu__decode_kernel_end
  s_load_dwordx16 s[72:87], s[0:1], 0
  s_load_dwordx4 s[88:91], s[0:1], 64
  s_load_dwordx2 s[96:97], s[0:1], 96
  v_and_b32 v1, 63, v0
  v_lshrrev_b32 v58, 6, v0
  s_and_b32 s44, s2, 7
  v_readfirstlane_b32 s3, v58
  s_lshr_b32 s45, s2, 3
  s_and_b32 s40, s45, 7
  s_lshr_b32 s45, s45, 3
  s_lshl_b32 s45, s45, 3
  s_add_u32 s41, s45, s44
  v_lshrrev_b32 v58, 3, v1
  v_and_b32 v59, 7, v1
  v_lshlrev_b32 v60, 4, v59
  v_mul_u32_u24 v3, 12288, v58
  v_add_u32 v3, v3, v60
  v_mul_u32_u24 v14, 20, v1
  s_waitcnt lgkmcnt(0)
  s_mul_i32 s44, s40, 1280
  s_add_u32 s28, s72, s44
  s_addc_u32 s29, s73, 0
  s_mov_b32 s30, 1280
  s_mov_b32 s31, 0x20000
  buffer_load_dwordx4 v[58:61], v14, s[28:31], 0 offen
  buffer_load_dword v62, v14, s[28:31], 0 offen offset:16
  s_mul_i32 s45, s3, 160
  v_lshlrev_b32 v16, 2, v1
  buffer_load_dword v38, v16, s[28:31], s45 offen
  s_mul_i32 s44, s41, 384
  s_sub_u32 s45, 7864320, s44
  s_add_u32 s12, s78, s44
  s_addc_u32 s13, s79, 0
  s_mov_b32 s14, s45
  s_mov_b32 s15, 0x20000
  s_mul_i32 s51, s3, 983040
  s_mov_b32 s50, s40
  s_mul_i32 s44, s50, 98304
  s_add_u32 s44, s44, s51
  buffer_load_dwordx4 v[112:115], v3, s[12:15], s44 offen offset:0
  buffer_load_dwordx4 v[116:119], v3, s[12:15], s44 offen offset:128
  buffer_load_dwordx4 v[120:123], v3, s[12:15], s44 offen offset:256
  s_add_u32 s50, s50, 1
  s_cmp_ge_u32 s50, 10
  s_cselect_b32 s47, 10, 0
  s_sub_u32 s50, s50, s47
  s_mul_i32 s44, s50, 98304
  s_add_u32 s44, s44, s51
  buffer_load_dwordx4 v[124:127], v3, s[12:15], s44 offen offset:0
  buffer_load_dwordx4 v[128:131], v3, s[12:15], s44 offen offset:128
  buffer_load_dwordx4 v[132:135], v3, s[12:15], s44 offen offset:256
  s_add_u32 s50, s50, 1
  s_cmp_ge_u32 s50, 10
  s_cselect_b32 s47, 10, 0
  s_sub_u32 s50, s50, s47
  v_lshrrev_b32 v22, 3, v1
  v_and_b32 v23, 7, v1
  v_lshlrev_b32 v24, 4, v23
  v_mul_u32_u24 v2, 384, v22
  v_add_u32 v2, v2, v24
  v_mul_u32_u24 v4, 3072, v22
  v_add_u32 v4, v4, v24
  v_lshrrev_b32 v25, 4, v1
  v_and_b32 v26, 15, v1
  v_lshlrev_b32 v27, 4, v26
  v_mul_u32_u24 v5, 1280, v25
  v_add_u32 v5, v5, v27
  v_lshrrev_b32 v15, 3, v1
  s_mul_i32 s46, s3, 8
  v_add_u32 v15, s46, v15
  v_lshlrev_b32 v15, 1, v15
  v_and_b32 v28, 1, v1
  v_lshlrev_b32 v28, 4, v28
  v_mov_b32 v29, 0xffff
  v_lshlrev_b32 v28, v28, v29
  v_lshrrev_b32 v23, 1, v23
  v_lshrrev_b32 v26, 1, v26
  v_cmp_eq_u32 vcc, 0, v23
  s_nop 1
  v_cndmask_b32 v6, 0, v28, vcc
  v_cmp_eq_u32 vcc, 0, v26
  s_nop 1
  v_cndmask_b32 v10, 0, v28, vcc
  v_cmp_eq_u32 vcc, 1, v23
  s_nop 1
  v_cndmask_b32 v7, 0, v28, vcc
  v_cmp_eq_u32 vcc, 1, v26
  s_nop 1
  v_cndmask_b32 v11, 0, v28, vcc
  v_cmp_eq_u32 vcc, 2, v23
  s_nop 1
  v_cndmask_b32 v8, 0, v28, vcc
  v_cmp_eq_u32 vcc, 2, v26
  s_nop 1
  v_cndmask_b32 v12, 0, v28, vcc
  v_cmp_eq_u32 vcc, 3, v23
  s_nop 1
  v_cndmask_b32 v9, 0, v28, vcc
  v_cmp_eq_u32 vcc, 3, v26
  s_nop 1
  v_cndmask_b32 v13, 0, v28, vcc
  s_lshl_b32 s44, s41, 7
  s_sub_u32 s45, 1966080, s44
  s_cmp_lt_u32 s41, 24
  s_cselect_b32 s45, s45, 0
  s_cselect_b32 s46, 128, 0
  s_cselect_b32 s47, 81920, 0
  s_add_u32 s20, s84, s44
  s_addc_u32 s21, s85, 0
  s_mov_b32 s22, s45
  s_mov_b32 s23, 0x20000
  s_add_u32 s32, s86, s44
  s_addc_u32 s33, s87, 0
  s_mov_b32 s34, s46
  s_mov_b32 s35, 0x20000
  s_mul_i32 s44, s41, 81920
  s_add_u32 s24, s88, s44
  s_addc_u32 s25, s89, 0
  s_mov_b32 s26, s47
  s_mov_b32 s27, 0x20000
  buffer_load_ushort v63, v15, s[32:35], 0 offen
  s_lshl_b32 s44, s40, 5
  s_add_u32 s44, s44, s41
  s_mul_i32 s44, s44, 1572864
  s_add_u32 s4, s74, s44
  s_addc_u32 s5, s75, 0
  s_mov_b32 s6, 1572864
  s_mov_b32 s7, 0x20000
  s_add_u32 s8, s76, s44
  s_addc_u32 s9, s77, 0
  s_mov_b32 s10, 1572864
  s_mov_b32 s11, 0x20000
  s_and_b32 s44, s2, 7
  s_mul_i32 s44, s44, 132
  s_lshr_b32 s45, s2, 3
  s_mul_i32 s45, s45, 6
  s_add_u32 s43, s44, s45
  s_lshl_b32 s44, s3, 1
  s_add_u32 s43, s43, s44
  s_mov_b32 s42, 0
  s_mul_i32 s44, s41, 245760
  s_add_u32 s16, s80, s44
  s_addc_u32 s17, s81, 0
  s_mov_b32 s18, 245760
  s_mov_b32 s19, 0x20000
  s_mov_b32 s36, s96
  s_mov_b32 s37, s97
  s_mov_b32 s38, 16777216
  s_mov_b32 s39, 0x20000
  s_mov_b32 s52, 0x1010101
  s_mov_b32 s53, 0x1010101
  s_mov_b32 s54, 0x2020202
  s_mov_b32 s55, 0x2020202
  s_mov_b32 s56, 0x4040404
  s_mov_b32 s57, 0x4040404
  s_mov_b32 s58, 0x8080808
  s_mov_b32 s59, 0x8080808
  s_mov_b32 s60, 0x10101010
  s_mov_b32 s61, 0x10101010
  s_mov_b32 s62, 0x20202020
  s_mov_b32 s63, 0x20202020
  s_mov_b32 s64, 0x40404040
  s_mov_b32 s65, 0x40404040
  s_mov_b32 s66, 0x80808080
  s_mov_b32 s67, 0x80808080
  s_waitcnt vmcnt(7)
  v_lshlrev_b32 v22, 16, v58
  v_and_b32 v23, 0xffff0000, v58
  v_lshlrev_b32 v24, 16, v59
  v_and_b32 v25, 0xffff0000, v59
  v_lshlrev_b32 v26, 16, v60
  v_and_b32 v27, 0xffff0000, v60
  v_lshlrev_b32 v28, 16, v61
  v_and_b32 v29, 0xffff0000, v61
  v_lshlrev_b32 v30, 16, v62
  v_and_b32 v31, 0xffff0000, v62
  v_add_f32 v32, v22, v23
  v_add_f32 v33, v24, v25
  v_add_f32 v34, v26, v27
  v_add_f32 v35, v28, v29
  v_add_f32 v32, v32, v33
  v_add_f32 v34, v34, v35
  v_add_f32 v33, v30, v31
  v_add_f32 v32, v32, v34
  v_add_f32 v32, v32, v33
  s_nop 1
  v_add_f32_dpp v32, v32, v32 row_ror:8 row_mask:0xf bank_mask:0xf
  s_nop 1
  v_add_f32_dpp v32, v32, v32 row_ror:4 row_mask:0xf bank_mask:0xf
  s_nop 1
  v_add_f32_dpp v32, v32, v32 row_ror:2 row_mask:0xf bank_mask:0xf
  s_nop 1
  v_add_f32_dpp v32, v32, v32 row_ror:1 row_mask:0xf bank_mask:0xf
  v_mov_b32 v33, v32
  s_nop 1
  v_permlane16_swap_b32 v32, v33
  s_nop 0
  v_add_f32 v32, v32, v33
  v_mov_b32 v33, v32
  s_nop 1
  v_permlane32_swap_b32 v32, v33
  s_nop 0
  v_add_f32 v32, v32, v33
  v_mul_f32 v32, 0x3acccccd, v32
  v_sub_f32 v22, v22, v32
  v_sub_f32 v23, v23, v32
  v_sub_f32 v24, v24, v32
  v_sub_f32 v25, v25, v32
  v_sub_f32 v26, v26, v32
  v_sub_f32 v27, v27, v32
  v_sub_f32 v28, v28, v32
  v_sub_f32 v29, v29, v32
  v_sub_f32 v30, v30, v32
  v_sub_f32 v31, v31, v32
  v_mul_f32 v33, v22, v22
  v_mul_f32 v34, v23, v23
  v_fmac_f32 v33, v24, v24
  v_fmac_f32 v34, v25, v25
  v_fmac_f32 v33, v26, v26
  v_fmac_f32 v34, v27, v27
  v_fmac_f32 v33, v28, v28
  v_fmac_f32 v34, v29, v29
  v_fmac_f32 v33, v30, v30
  v_fmac_f32 v34, v31, v31
  v_add_f32 v33, v33, v34
  s_nop 1
  v_add_f32_dpp v33, v33, v33 row_ror:8 row_mask:0xf bank_mask:0xf
  s_nop 1
  v_add_f32_dpp v33, v33, v33 row_ror:4 row_mask:0xf bank_mask:0xf
  s_nop 1
  v_add_f32_dpp v33, v33, v33 row_ror:2 row_mask:0xf bank_mask:0xf
  s_nop 1
  v_add_f32_dpp v33, v33, v33 row_ror:1 row_mask:0xf bank_mask:0xf
  v_mov_b32 v34, v33
  s_nop 1
  v_permlane16_swap_b32 v33, v34
  s_nop 0
  v_add_f32 v33, v33, v34
  v_mov_b32 v34, v33
  s_nop 1
  v_permlane32_swap_b32 v33, v34
  s_nop 0
  v_add_f32 v33, v33, v34
  v_mul_f32 v33, 0x3acccccd, v33
  v_cvt_pk_bf16_f32 v32, v32, v32
  v_and_b32 v32, 0xffff0000, v32
  v_cvt_pk_bf16_f32 v33, v33, v33
  v_and_b32 v33, 0xffff0000, v33
  v_add_f32 v33, 0x3727c5ac, v33
  v_cvt_pk_bf16_f32 v33, v33, v33
  v_and_b32 v33, 0xffff0000, v33
  v_sqrt_f32 v33, v33
  v_lshlrev_b32 v22, 16, v38
  v_and_b32 v23, 0xffff0000, v38
  v_cvt_pk_bf16_f32 v33, v33, v33
  v_and_b32 v33, 0xffff0000, v33
  v_rcp_f32 v34, v33
  v_sub_f32 v22, v22, v32
  v_sub_f32 v23, v23, v32
  v_cvt_pk_bf16_f32 v22, v22, v22
  v_and_b32 v22, 0xffff0000, v22
  v_cvt_pk_bf16_f32 v23, v23, v23
  v_and_b32 v23, 0xffff0000, v23
  v_mul_f32 v24, v22, v34
  v_mul_f32 v25, v23, v34
  v_fma_f32 v26, -v24, v33, v22
  v_fma_f32 v27, -v25, v33, v23
  v_fma_f32 v24, v26, v34, v24
  v_fma_f32 v25, v27, v34, v25
  v_cvt_pk_bf16_f32 v22, v24, v24
  v_cvt_pk_bf16_f32 v23, v25, v25
  s_mul_i32 s44, s3, 320
  v_lshlrev_b32 v14, 3, v1
  v_add_u32 v14, s44, v14
  s_mov_b32 exec_hi, 0xff
  ds_write_b64 v14, v[22:23] offset:0
  s_mov_b64 exec, -1
  v_lshrrev_b32 v15, 3, v1
  v_lshlrev_b32 v15, 2, v15
  s_mul_i32 s44, s3, 320
  v_add_u32 v15, s44, v15
  s_lshl_b32 s45, s40, 5
  s_waitcnt lgkmcnt(0)
  v_add_u32 v16, s45, v15
  ds_read_b32 v232, v16 offset:0
  s_add_u32 s45, s45, 32
  s_cmp_ge_u32 s45, 320
  s_cselect_b32 s46, 320, 0
  s_sub_u32 s45, s45, s46
  v_add_u32 v16, s45, v15
  ds_read_b32 v233, v16 offset:0
  s_add_u32 s45, s45, 32
  s_cmp_ge_u32 s45, 320
  s_cselect_b32 s46, 320, 0
  s_sub_u32 s45, s45, s46
  v_add_u32 v16, s45, v15
  ds_read_b32 v234, v16 offset:0
  s_add_u32 s45, s45, 32
  s_cmp_ge_u32 s45, 320
  s_cselect_b32 s46, 320, 0
  s_sub_u32 s45, s45, s46
  v_add_u32 v16, s45, v15
  ds_read_b32 v235, v16 offset:0
  s_add_u32 s45, s45, 32
  s_cmp_ge_u32 s45, 320
  s_cselect_b32 s46, 320, 0
  s_sub_u32 s45, s45, s46
  v_add_u32 v16, s45, v15
  ds_read_b32 v236, v16 offset:0
  s_add_u32 s45, s45, 32
  s_cmp_ge_u32 s45, 320
  s_cselect_b32 s46, 320, 0
  s_sub_u32 s45, s45, s46
  v_add_u32 v16, s45, v15
  ds_read_b32 v237, v16 offset:0
  s_add_u32 s45, s45, 32
  s_cmp_ge_u32 s45, 320
  s_cselect_b32 s46, 320, 0
  s_sub_u32 s45, s45, s46
  v_add_u32 v16, s45, v15
  ds_read_b32 v238, v16 offset:0
  s_add_u32 s45, s45, 32
  s_cmp_ge_u32 s45, 320
  s_cselect_b32 s46, 320, 0
  s_sub_u32 s45, s45, s46
  v_add_u32 v16, s45, v15
  ds_read_b32 v239, v16 offset:0
  s_add_u32 s45, s45, 32
  s_cmp_ge_u32 s45, 320
  s_cselect_b32 s46, 320, 0
  s_sub_u32 s45, s45, s46
  v_add_u32 v16, s45, v15
  ds_read_b32 v240, v16 offset:0
  s_add_u32 s45, s45, 32
  s_cmp_ge_u32 s45, 320
  s_cselect_b32 s46, 320, 0
  s_sub_u32 s45, s45, s46
  v_add_u32 v16, s45, v15
  ds_read_b32 v241, v16 offset:0
  s_add_u32 s45, s45, 32
  s_cmp_ge_u32 s45, 320
  s_cselect_b32 s46, 320, 0
  s_sub_u32 s45, s45, s46
  s_mul_i32 s44, s50, 98304
  s_add_u32 s44, s44, s51
  buffer_load_dwordx4 v[136:139], v3, s[12:15], s44 offen offset:0
  buffer_load_dwordx4 v[140:143], v3, s[12:15], s44 offen offset:128
  buffer_load_dwordx4 v[144:147], v3, s[12:15], s44 offen offset:256
  s_add_u32 s50, s50, 1
  s_cmp_ge_u32 s50, 10
  s_cselect_b32 s47, 10, 0
  s_sub_u32 s50, s50, s47
  s_mul_i32 s44, s50, 98304
  s_add_u32 s44, s44, s51
  buffer_load_dwordx4 v[148:151], v3, s[12:15], s44 offen offset:0
  buffer_load_dwordx4 v[152:155], v3, s[12:15], s44 offen offset:128
  buffer_load_dwordx4 v[156:159], v3, s[12:15], s44 offen offset:256
  s_add_u32 s50, s50, 1
  s_cmp_ge_u32 s50, 10
  s_cselect_b32 s47, 10, 0
  s_sub_u32 s50, s50, s47
  s_mul_i32 s44, s50, 98304
  s_add_u32 s44, s44, s51
  buffer_load_dwordx4 v[160:163], v3, s[12:15], s44 offen offset:0
  buffer_load_dwordx4 v[164:167], v3, s[12:15], s44 offen offset:128
  buffer_load_dwordx4 v[168:171], v3, s[12:15], s44 offen offset:256
  s_add_u32 s50, s50, 1
  s_cmp_ge_u32 s50, 10
  s_cselect_b32 s47, 10, 0
  s_sub_u32 s50, s50, s47
  s_mul_i32 s44, s50, 98304
  s_add_u32 s44, s44, s51
  buffer_load_dwordx4 v[172:175], v3, s[12:15], s44 offen offset:0
  buffer_load_dwordx4 v[176:179], v3, s[12:15], s44 offen offset:128
  buffer_load_dwordx4 v[180:183], v3, s[12:15], s44 offen offset:256
  s_add_u32 s50, s50, 1
  s_cmp_ge_u32 s50, 10
  s_cselect_b32 s47, 10, 0
  s_sub_u32 s50, s50, s47
  s_mul_i32 s44, s50, 98304
  s_add_u32 s44, s44, s51
  buffer_load_dwordx4 v[184:187], v3, s[12:15], s44 offen offset:0
  buffer_load_dwordx4 v[188:191], v3, s[12:15], s44 offen offset:128
  buffer_load_dwordx4 v[192:195], v3, s[12:15], s44 offen offset:256
  s_add_u32 s50, s50, 1
  s_cmp_ge_u32 s50, 10
  s_cselect_b32 s47, 10, 0
  s_sub_u32 s50, s50, s47
  s_mul_i32 s44, s50, 98304
  s_add_u32 s44, s44, s51
  buffer_load_dwordx4 v[196:199], v3, s[12:15], s44 offen offset:0
  buffer_load_dwordx4 v[200:203], v3, s[12:15], s44 offen offset:128
  buffer_load_dwordx4 v[204:207], v3, s[12:15], s44 offen offset:256
  s_add_u32 s50, s50, 1
  s_cmp_ge_u32 s50, 10
  s_cselect_b32 s47, 10, 0
  s_sub_u32 s50, s50, s47
  s_mul_i32 s44, s50, 98304
  s_add_u32 s44, s44, s51
  buffer_load_dwordx4 v[208:211], v3, s[12:15], s44 offen offset:0
  buffer_load_dwordx4 v[212:215], v3, s[12:15], s44 offen offset:128
  buffer_load_dwordx4 v[216:219], v3, s[12:15], s44 offen offset:256
  s_add_u32 s50, s50, 1
  s_cmp_ge_u32 s50, 10
  s_cselect_b32 s47, 10, 0
  s_sub_u32 s50, s50, s47
  s_mul_i32 s44, s50, 98304
  s_add_u32 s44, s44, s51
  buffer_load_dwordx4 v[220:223], v3, s[12:15], s44 offen offset:0
  buffer_load_dwordx4 v[224:227], v3, s[12:15], s44 offen offset:128
  buffer_load_dwordx4 v[228:231], v3, s[12:15], s44 offen offset:256
  s_add_u32 s50, s50, 1
  s_cmp_ge_u32 s50, 10
  s_cselect_b32 s47, 10, 0
  s_sub_u32 s50, s50, s47
  s_lshr_b32 s46, s42, 1
  s_lshl_b32 s46, s46, 4
  s_and_b32 s47, s42, 1
  s_add_u32 s48, s46, s47
  s_add_u32 s48, s48, s43
  s_and_b32 s48, s48, 511
  s_mul_i32 s48, s48, 3072
  s_add_u32 s42, s42, 1
  s_and_b32 s42, s42, 63
  buffer_load_dwordx4 v[64:67], v2, s[4:7], s48 offen offset:0 nt
  buffer_load_dwordx4 v[68:71], v2, s[4:7], s48 offen offset:128 nt
  buffer_load_dwordx4 v[72:75], v2, s[4:7], s48 offen offset:256 nt
  s_lshr_b32 s46, s42, 1
  s_lshl_b32 s46, s46, 4
  s_and_b32 s47, s42, 1
  s_add_u32 s48, s46, s47
  s_add_u32 s48, s48, s43
  s_and_b32 s48, s48, 511
  s_mul_i32 s48, s48, 3072
  s_add_u32 s42, s42, 1
  s_and_b32 s42, s42, 63
  buffer_load_dwordx4 v[76:79], v2, s[4:7], s48 offen offset:0 nt
  buffer_load_dwordx4 v[80:83], v2, s[4:7], s48 offen offset:128 nt
  buffer_load_dwordx4 v[84:87], v2, s[4:7], s48 offen offset:256 nt
  s_waitcnt lgkmcnt(9)
  v_and_b32 v14, v232, v6
  v_and_b32 v15, v232, v7
  v_and_b32 v16, v232, v8
  v_and_b32 v17, v232, v9
  s_waitcnt vmcnt(34)
  s_nop 0
  v_mfma_f32_16x16x32_bf16 v[22:25], v[14:17], v[112:115], 0
  v_mfma_f32_16x16x32_bf16 v[26:29], v[14:17], v[116:119], 0
  v_mfma_f32_16x16x32_bf16 v[30:33], v[14:17], v[120:123], 0
  s_waitcnt lgkmcnt(8)
  v_and_b32 v18, v233, v6
  v_and_b32 v19, v233, v7
  v_and_b32 v20, v233, v8
  v_and_b32 v21, v233, v9
  s_waitcnt vmcnt(31)
  s_nop 0
  v_mfma_f32_16x16x32_bf16 v[22:25], v[18:21], v[124:127], v[22:25]
  v_mfma_f32_16x16x32_bf16 v[26:29], v[18:21], v[128:131], v[26:29]
  v_mfma_f32_16x16x32_bf16 v[30:33], v[18:21], v[132:135], v[30:33]
  s_waitcnt lgkmcnt(7)
  v_and_b32 v14, v234, v6
  v_and_b32 v15, v234, v7
  v_and_b32 v16, v234, v8
  v_and_b32 v17, v234, v9
  s_waitcnt vmcnt(27)
  s_nop 0
  v_mfma_f32_16x16x32_bf16 v[22:25], v[14:17], v[136:139], v[22:25]
  v_mfma_f32_16x16x32_bf16 v[26:29], v[14:17], v[140:143], v[26:29]
  v_mfma_f32_16x16x32_bf16 v[30:33], v[14:17], v[144:147], v[30:33]
  s_waitcnt lgkmcnt(6)
  v_and_b32 v18, v235, v6
  v_and_b32 v19, v235, v7
  v_and_b32 v20, v235, v8
  v_and_b32 v21, v235, v9
  s_waitcnt vmcnt(24)
  s_nop 0
  v_mfma_f32_16x16x32_bf16 v[22:25], v[18:21], v[148:151], v[22:25]
  v_mfma_f32_16x16x32_bf16 v[26:29], v[18:21], v[152:155], v[26:29]
  v_mfma_f32_16x16x32_bf16 v[30:33], v[18:21], v[156:159], v[30:33]
  s_waitcnt lgkmcnt(5)
  v_and_b32 v14, v236, v6
  v_and_b32 v15, v236, v7
  v_and_b32 v16, v236, v8
  v_and_b32 v17, v236, v9
  s_waitcnt vmcnt(21)
  s_nop 0
  v_mfma_f32_16x16x32_bf16 v[22:25], v[14:17], v[160:163], v[22:25]
  v_mfma_f32_16x16x32_bf16 v[26:29], v[14:17], v[164:167], v[26:29]
  v_mfma_f32_16x16x32_bf16 v[30:33], v[14:17], v[168:171], v[30:33]
  s_waitcnt lgkmcnt(4)
  v_and_b32 v18, v237, v6
  v_and_b32 v19, v237, v7
  v_and_b32 v20, v237, v8
  v_and_b32 v21, v237, v9
  s_waitcnt vmcnt(18)
  s_nop 0
  v_mfma_f32_16x16x32_bf16 v[22:25], v[18:21], v[172:175], v[22:25]
  v_mfma_f32_16x16x32_bf16 v[26:29], v[18:21], v[176:179], v[26:29]
  v_mfma_f32_16x16x32_bf16 v[30:33], v[18:21], v[180:183], v[30:33]
  s_waitcnt lgkmcnt(3)
  v_and_b32 v14, v238, v6
  v_and_b32 v15, v238, v7
  v_and_b32 v16, v238, v8
  v_and_b32 v17, v238, v9
  s_waitcnt vmcnt(15)
  s_nop 0
  v_mfma_f32_16x16x32_bf16 v[22:25], v[14:17], v[184:187], v[22:25]
  v_mfma_f32_16x16x32_bf16 v[26:29], v[14:17], v[188:191], v[26:29]
  v_mfma_f32_16x16x32_bf16 v[30:33], v[14:17], v[192:195], v[30:33]
  s_waitcnt lgkmcnt(2)
  v_and_b32 v18, v239, v6
  v_and_b32 v19, v239, v7
  v_and_b32 v20, v239, v8
  v_and_b32 v21, v239, v9
  s_waitcnt vmcnt(12)
  s_nop 0
  v_mfma_f32_16x16x32_bf16 v[22:25], v[18:21], v[196:199], v[22:25]
  v_mfma_f32_16x16x32_bf16 v[26:29], v[18:21], v[200:203], v[26:29]
  v_mfma_f32_16x16x32_bf16 v[30:33], v[18:21], v[204:207], v[30:33]
  s_waitcnt lgkmcnt(1)
  v_and_b32 v14, v240, v6
  v_and_b32 v15, v240, v7
  v_and_b32 v16, v240, v8
  v_and_b32 v17, v240, v9
  s_waitcnt vmcnt(9)
  s_nop 0
  v_mfma_f32_16x16x32_bf16 v[22:25], v[14:17], v[208:211], v[22:25]
  v_mfma_f32_16x16x32_bf16 v[26:29], v[14:17], v[212:215], v[26:29]
  v_mfma_f32_16x16x32_bf16 v[30:33], v[14:17], v[216:219], v[30:33]
  s_waitcnt lgkmcnt(0)
  v_and_b32 v18, v241, v6
  v_and_b32 v19, v241, v7
  v_and_b32 v20, v241, v8
  v_and_b32 v21, v241, v9
  s_waitcnt vmcnt(6)
  s_nop 0
  v_mfma_f32_16x16x32_bf16 v[22:25], v[18:21], v[220:223], v[22:25]
  v_mfma_f32_16x16x32_bf16 v[26:29], v[18:21], v[224:227], v[26:29]
  v_mfma_f32_16x16x32_bf16 v[30:33], v[18:21], v[228:231], v[30:33]
  s_lshr_b32 s46, s42, 1
  s_lshl_b32 s46, s46, 4
  s_and_b32 s47, s42, 1
  s_add_u32 s48, s46, s47
  s_add_u32 s48, s48, s43
  s_and_b32 s48, s48, 511
  s_mul_i32 s48, s48, 3072
  s_add_u32 s42, s42, 1
  s_and_b32 s42, s42, 63
  buffer_load_dwordx4 v[88:91], v2, s[4:7], s48 offen offset:0 nt
  buffer_load_dwordx4 v[92:95], v2, s[4:7], s48 offen offset:128 nt
  buffer_load_dwordx4 v[96:99], v2, s[4:7], s48 offen offset:256 nt
  s_lshr_b32 s46, s42, 1
  s_lshl_b32 s46, s46, 4
  s_and_b32 s47, s42, 1
  s_add_u32 s48, s46, s47
  s_add_u32 s48, s48, s43
  s_and_b32 s48, s48, 511
  s_mul_i32 s48, s48, 3072
  s_add_u32 s42, s42, 1
  s_and_b32 s42, s42, 63
  buffer_load_dwordx4 v[100:103], v2, s[4:7], s48 offen offset:0 nt
  buffer_load_dwordx4 v[104:107], v2, s[4:7], s48 offen offset:128 nt
  buffer_load_dwordx4 v[108:111], v2, s[4:7], s48 offen offset:256 nt
  v_lshrrev_b32 v58, 5, v1
  s_lshl_b32 s44, s3, 1
  v_add_u32 v58, s44, v58
  v_and_b32 v59, 7, v1
  v_lshlrev_b32 v59, 5, v59
  v_and_b32 v60, 16, v1
  v_add_u32 v59, v59, v60
  v_lshlrev_b32 v60, 10, v58
  v_add_u32 v60, v60, v59
  s_nop 1
  s_mov_b32 exec_lo, 0x00ff00ff
  s_mov_b32 exec_hi, 0xff00ff00
  ds_write_b128 v60, v[22:25] offset:2560
  ds_write_b128 v60, v[26:29] offset:2816
  ds_write_b128 v60, v[30:33] offset:3072
  s_mov_b64 exec, -1
  s_waitcnt lgkmcnt(0)
  s_barrier
  s_cmp_ge_u32 s3, 3
  s_cbranch_scc1 recurrent_scan__mha_block_cached__dense_activation_squared_relu__decode_kernel_skip_red1
  v_lshlrev_b32 v58, 2, v0
  ds_read2st64_b32 v[22:23], v58 offset0:10 offset1:14
  ds_read2st64_b32 v[24:25], v58 offset0:18 offset1:22
  ds_read2st64_b32 v[26:27], v58 offset0:26 offset1:30
  ds_read2st64_b32 v[28:29], v58 offset0:34 offset1:38
  ds_read2st64_b32 v[30:31], v58 offset0:42 offset1:46
  ds_read2st64_b32 v[32:33], v58 offset0:50 offset1:54
  ds_read2st64_b32 v[34:35], v58 offset0:58 offset1:62
  ds_read2st64_b32 v[36:37], v58 offset0:66 offset1:70
  s_waitcnt lgkmcnt(0)
  v_add_f32 v22, v22, v23
  v_add_f32 v24, v24, v25
  v_add_f32 v26, v26, v27
  v_add_f32 v28, v28, v29
  v_add_f32 v30, v30, v31
  v_add_f32 v32, v32, v33
  v_add_f32 v34, v34, v35
  v_add_f32 v36, v36, v37
  v_add_f32 v22, v22, v24
  v_add_f32 v26, v26, v28
  v_add_f32 v30, v30, v32
  v_add_f32 v34, v34, v36
  v_add_f32 v22, v22, v26
  v_add_f32 v30, v30, v34
  v_add_f32 v22, v22, v30
  v_cvt_pk_bf16_f32 v22, v22, v22
  v_lshlrev_b32 v58, 1, v0
  ds_write_b16 v58, v22 offset:18944
  s_waitcnt lgkmcnt(0)
recurrent_scan__mha_block_cached__dense_activation_squared_relu__decode_kernel_skip_red1:
  s_barrier
  v_and_b32 v58, 7, v1
  v_lshlrev_b32 v58, 4, v58
  ds_read_b128 v[46:49], v58 offset:18944
  ds_read_b128 v[50:53], v58 offset:19072
  ds_read_b128 v[54:57], v58 offset:19200
  v_and_b32 v62, 15, v1
  v_lshlrev_b32 v62, 5, v62
  v_and_b32 v61, 16, v1
  v_add_u32 v62, v62, v61
  s_mul_i32 s44, s3, 2560
  v_add_u32 v62, s44, v62
  s_waitcnt lgkmcnt(0)
  s_waitcnt vmcnt(9)
  v_dot2_f32_bf16 v58, v64, v46, 0
  v_dot2_f32_bf16 v59, v68, v50, 0
  v_dot2_f32_bf16 v58, v72, v54, v58
  v_dot2_f32_bf16 v59, v65, v47, v59
  v_dot2_f32_bf16 v58, v69, v51, v58
  v_dot2_f32_bf16 v59, v73, v55, v59
  v_dot2_f32_bf16 v58, v66, v48, v58
  v_dot2_f32_bf16 v59, v70, v52, v59
  v_dot2_f32_bf16 v58, v74, v56, v58
  v_dot2_f32_bf16 v59, v67, v49, v59
  v_dot2_f32_bf16 v58, v71, v53, v58
  v_dot2_f32_bf16 v59, v75, v57, v59
  s_nop 2
  v_add_f32 v58, v58, v59
  s_nop 1
  v_add_f32_dpp v58, v58, v58 quad_perm:[1,0,3,2] row_mask:0xf bank_mask:0xf
  s_nop 1
  v_add_f32_dpp v58, v58, v58 quad_perm:[2,3,0,1] row_mask:0xf bank_mask:0xf
  s_nop 1
  v_add_f32_dpp v58, v58, v58 row_half_mirror row_mask:0xf bank_mask:0xf
  v_mov_b32 v38, v58
  s_waitcnt vmcnt(6)
  v_dot2_f32_bf16 v58, v76, v46, 0
  v_dot2_f32_bf16 v59, v80, v50, 0
  v_dot2_f32_bf16 v58, v84, v54, v58
  v_dot2_f32_bf16 v59, v77, v47, v59
  v_dot2_f32_bf16 v58, v81, v51, v58
  v_dot2_f32_bf16 v59, v85, v55, v59
  v_dot2_f32_bf16 v58, v78, v48, v58
  v_dot2_f32_bf16 v59, v82, v52, v59
  v_dot2_f32_bf16 v58, v86, v56, v58
  v_dot2_f32_bf16 v59, v79, v49, v59
  v_dot2_f32_bf16 v58, v83, v53, v58
  v_dot2_f32_bf16 v59, v87, v57, v59
  s_nop 2
  v_add_f32 v58, v58, v59
  s_nop 1
  v_add_f32_dpp v58, v58, v58 quad_perm:[1,0,3,2] row_mask:0xf bank_mask:0xf
  s_nop 1
  v_add_f32_dpp v58, v58, v58 quad_perm:[2,3,0,1] row_mask:0xf bank_mask:0xf
  s_nop 1
  v_add_f32_dpp v58, v58, v58 row_half_mirror row_mask:0xf bank_mask:0xf
  v_cndmask_b32 v38, v38, v58, s[54:55]
  s_waitcnt vmcnt(3)
  v_dot2_f32_bf16 v58, v88, v46, 0
  v_dot2_f32_bf16 v59, v92, v50, 0
  v_dot2_f32_bf16 v58, v96, v54, v58
  v_dot2_f32_bf16 v59, v89, v47, v59
  v_dot2_f32_bf16 v58, v93, v51, v58
  v_dot2_f32_bf16 v59, v97, v55, v59
  v_dot2_f32_bf16 v58, v90, v48, v58
  v_dot2_f32_bf16 v59, v94, v52, v59
  v_dot2_f32_bf16 v58, v98, v56, v58
  v_dot2_f32_bf16 v59, v91, v49, v59
  v_dot2_f32_bf16 v58, v95, v53, v58
  v_dot2_f32_bf16 v59, v99, v57, v59
  s_nop 2
  v_add_f32 v58, v58, v59
  s_nop 1
  v_add_f32_dpp v58, v58, v58 quad_perm:[1,0,3,2] row_mask:0xf bank_mask:0xf
  s_nop 1
  v_add_f32_dpp v58, v58, v58 quad_perm:[2,3,0,1] row_mask:0xf bank_mask:0xf
  s_nop 1
  v_add_f32_dpp v58, v58, v58 row_half_mirror row_mask:0xf bank_mask:0xf
  v_cndmask_b32 v38, v38, v58, s[56:57]
  s_lshr_b32 s46, s42, 1
  s_lshl_b32 s46, s46, 4
  s_and_b32 s47, s42, 1
  s_add_u32 s48, s46, s47
  s_add_u32 s48, s48, s43
  s_and_b32 s48, s48, 511
  s_mul_i32 s48, s48, 3072
  s_add_u32 s42, s42, 1
  s_and_b32 s42, s42, 63
  s_waitcnt vmcnt(0)
  buffer_load_dwordx4 v[64:67], v2, s[4:7], s48 offen offset:0 nt
  buffer_load_dwordx4 v[68:71], v2, s[4:7], s48 offen offset:128 nt
  buffer_load_dwordx4 v[72:75], v2, s[4:7], s48 offen offset:256 nt
  v_dot2_f32_bf16 v58, v100, v46, 0
  v_dot2_f32_bf16 v59, v104, v50, 0
  v_dot2_f32_bf16 v58, v108, v54, v58
  v_dot2_f32_bf16 v59, v101, v47, v59
  v_dot2_f32_bf16 v58, v105, v51, v58
  v_dot2_f32_bf16 v59, v109, v55, v59
  v_dot2_f32_bf16 v58, v102, v48, v58
  v_dot2_f32_bf16 v59, v106, v52, v59
  v_dot2_f32_bf16 v58, v110, v56, v58
  v_dot2_f32_bf16 v59, v103, v49, v59
  v_dot2_f32_bf16 v58, v107, v53, v58
  v_dot2_f32_bf16 v59, v111, v57, v59
  s_nop 2
  v_add_f32 v58, v58, v59
  s_nop 1
  v_add_f32_dpp v58, v58, v58 quad_perm:[1,0,3,2] row_mask:0xf bank_mask:0xf
  s_nop 1
  v_add_f32_dpp v58, v58, v58 quad_perm:[2,3,0,1] row_mask:0xf bank_mask:0xf
  s_nop 1
  v_add_f32_dpp v58, v58, v58 row_half_mirror row_mask:0xf bank_mask:0xf
  v_cndmask_b32 v38, v38, v58, s[58:59]
  s_lshr_b32 s46, s42, 1
  s_lshl_b32 s46, s46, 4
  s_and_b32 s47, s42, 1
  s_add_u32 s48, s46, s47
  s_add_u32 s48, s48, s43
  s_and_b32 s48, s48, 511
  s_mul_i32 s48, s48, 3072
  s_add_u32 s42, s42, 1
  s_and_b32 s42, s42, 63
  s_waitcnt vmcnt(0)
  buffer_load_dwordx4 v[76:79], v2, s[4:7], s48 offen offset:0 nt
  buffer_load_dwordx4 v[80:83], v2, s[4:7], s48 offen offset:128 nt
  buffer_load_dwordx4 v[84:87], v2, s[4:7], s48 offen offset:256 nt
  v_dot2_f32_bf16 v58, v64, v46, 0
  v_dot2_f32_bf16 v59, v68, v50, 0
  v_dot2_f32_bf16 v58, v72, v54, v58
  v_dot2_f32_bf16 v59, v65, v47, v59
  v_dot2_f32_bf16 v58, v69, v51, v58
  v_dot2_f32_bf16 v59, v73, v55, v59
  v_dot2_f32_bf16 v58, v66, v48, v58
  v_dot2_f32_bf16 v59, v70, v52, v59
  v_dot2_f32_bf16 v58, v74, v56, v58
  v_dot2_f32_bf16 v59, v67, v49, v59
  v_dot2_f32_bf16 v58, v71, v53, v58
  v_dot2_f32_bf16 v59, v75, v57, v59
  s_nop 2
  v_add_f32 v58, v58, v59
  s_nop 1
  v_add_f32_dpp v58, v58, v58 quad_perm:[1,0,3,2] row_mask:0xf bank_mask:0xf
  s_nop 1
  v_add_f32_dpp v58, v58, v58 quad_perm:[2,3,0,1] row_mask:0xf bank_mask:0xf
  s_nop 1
  v_add_f32_dpp v58, v58, v58 row_half_mirror row_mask:0xf bank_mask:0xf
  v_cndmask_b32 v38, v38, v58, s[60:61]
  s_lshr_b32 s46, s42, 1
  s_lshl_b32 s46, s46, 4
  s_and_b32 s47, s42, 1
  s_add_u32 s48, s46, s47
  s_add_u32 s48, s48, s43
  s_and_b32 s48, s48, 511
  s_mul_i32 s48, s48, 3072
  s_add_u32 s42, s42, 1
  s_and_b32 s42, s42, 63
  s_waitcnt vmcnt(0)
  buffer_load_dwordx4 v[88:91], v2, s[4:7], s48 offen offset:0 nt
  buffer_load_dwordx4 v[92:95], v2, s[4:7], s48 offen offset:128 nt
  buffer_load_dwordx4 v[96:99], v2, s[4:7], s48 offen offset:256 nt
  v_dot2_f32_bf16 v58, v76, v46, 0
  v_dot2_f32_bf16 v59, v80, v50, 0
  v_dot2_f32_bf16 v58, v84, v54, v58
  v_dot2_f32_bf16 v59, v77, v47, v59
  v_dot2_f32_bf16 v58, v81, v51, v58
  v_dot2_f32_bf16 v59, v85, v55, v59
  v_dot2_f32_bf16 v58, v78, v48, v58
  v_dot2_f32_bf16 v59, v82, v52, v59
  v_dot2_f32_bf16 v58, v86, v56, v58
  v_dot2_f32_bf16 v59, v79, v49, v59
  v_dot2_f32_bf16 v58, v83, v53, v58
  v_dot2_f32_bf16 v59, v87, v57, v59
  s_nop 2
  v_add_f32 v58, v58, v59
  s_nop 1
  v_add_f32_dpp v58, v58, v58 quad_perm:[1,0,3,2] row_mask:0xf bank_mask:0xf
  s_nop 1
  v_add_f32_dpp v58, v58, v58 quad_perm:[2,3,0,1] row_mask:0xf bank_mask:0xf
  s_nop 1
  v_add_f32_dpp v58, v58, v58 row_half_mirror row_mask:0xf bank_mask:0xf
  v_cndmask_b32 v38, v38, v58, s[62:63]
  s_lshr_b32 s46, s42, 1
  s_lshl_b32 s46, s46, 4
  s_and_b32 s47, s42, 1
  s_add_u32 s48, s46, s47
  s_add_u32 s48, s48, s43
  s_and_b32 s48, s48, 511
  s_mul_i32 s48, s48, 3072
  s_add_u32 s42, s42, 1
  s_and_b32 s42, s42, 63
  s_waitcnt vmcnt(0)
  buffer_load_dwordx4 v[100:103], v2, s[4:7], s48 offen offset:0 nt
  buffer_load_dwordx4 v[104:107], v2, s[4:7], s48 offen offset:128 nt
  buffer_load_dwordx4 v[108:111], v2, s[4:7], s48 offen offset:256 nt
  v_dot2_f32_bf16 v58, v88, v46, 0
  v_dot2_f32_bf16 v59, v92, v50, 0
  v_dot2_f32_bf16 v58, v96, v54, v58
  v_dot2_f32_bf16 v59, v89, v47, v59
  v_dot2_f32_bf16 v58, v93, v51, v58
  v_dot2_f32_bf16 v59, v97, v55, v59
  v_dot2_f32_bf16 v58, v90, v48, v58
  v_dot2_f32_bf16 v59, v94, v52, v59
  v_dot2_f32_bf16 v58, v98, v56, v58
  v_dot2_f32_bf16 v59, v91, v49, v59
  v_dot2_f32_bf16 v58, v95, v53, v58
  v_dot2_f32_bf16 v59, v99, v57, v59
  s_nop 2
  v_add_f32 v58, v58, v59
  s_nop 1
  v_add_f32_dpp v58, v58, v58 quad_perm:[1,0,3,2] row_mask:0xf bank_mask:0xf
  s_nop 1
  v_add_f32_dpp v58, v58, v58 quad_perm:[2,3,0,1] row_mask:0xf bank_mask:0xf
  s_nop 1
  v_add_f32_dpp v58, v58, v58 row_half_mirror row_mask:0xf bank_mask:0xf
  v_cndmask_b32 v38, v38, v58, s[64:65]
  s_lshr_b32 s46, s42, 1
  s_lshl_b32 s46, s46, 4
  s_and_b32 s47, s42, 1
  s_add_u32 s48, s46, s47
  s_add_u32 s48, s48, s43
  s_and_b32 s48, s48, 511
  s_mul_i32 s48, s48, 3072
  s_add_u32 s42, s42, 1
  s_and_b32 s42, s42, 63
  s_waitcnt vmcnt(0)
  buffer_load_dwordx4 v[64:67], v2, s[4:7], s48 offen offset:0 nt
  buffer_load_dwordx4 v[68:71], v2, s[4:7], s48 offen offset:128 nt
  buffer_load_dwordx4 v[72:75], v2, s[4:7], s48 offen offset:256 nt
  v_dot2_f32_bf16 v58, v100, v46, 0
  v_dot2_f32_bf16 v59, v104, v50, 0
  v_dot2_f32_bf16 v58, v108, v54, v58
  v_dot2_f32_bf16 v59, v101, v47, v59
  v_dot2_f32_bf16 v58, v105, v51, v58
  v_dot2_f32_bf16 v59, v109, v55, v59
  v_dot2_f32_bf16 v58, v102, v48, v58
  v_dot2_f32_bf16 v59, v106, v52, v59
  v_dot2_f32_bf16 v58, v110, v56, v58
  v_dot2_f32_bf16 v59, v103, v49, v59
  v_dot2_f32_bf16 v58, v107, v53, v58
  v_dot2_f32_bf16 v59, v111, v57, v59
  s_nop 2
  v_add_f32 v58, v58, v59
  s_nop 1
  v_add_f32_dpp v58, v58, v58 quad_perm:[1,0,3,2] row_mask:0xf bank_mask:0xf
  s_nop 1
  v_add_f32_dpp v58, v58, v58 quad_perm:[2,3,0,1] row_mask:0xf bank_mask:0xf
  s_nop 1
  v_add_f32_dpp v58, v58, v58 row_half_mirror row_mask:0xf bank_mask:0xf
  v_cndmask_b32 v38, v38, v58, s[66:67]
  s_lshr_b32 s46, s42, 1
  s_lshl_b32 s46, s46, 4
  s_and_b32 s47, s42, 1
  s_add_u32 s48, s46, s47
  s_add_u32 s48, s48, s43
  s_and_b32 s48, s48, 511
  s_mul_i32 s48, s48, 3072
  s_add_u32 s42, s42, 1
  s_and_b32 s42, s42, 63
  s_waitcnt vmcnt(0)
  buffer_load_dwordx4 v[76:79], v2, s[4:7], s48 offen offset:0 nt
  buffer_load_dwordx4 v[80:83], v2, s[4:7], s48 offen offset:128 nt
  buffer_load_dwordx4 v[84:87], v2, s[4:7], s48 offen offset:256 nt
  v_dot2_f32_bf16 v58, v64, v46, 0
  v_dot2_f32_bf16 v59, v68, v50, 0
  v_dot2_f32_bf16 v58, v72, v54, v58
  v_dot2_f32_bf16 v59, v65, v47, v59
  v_dot2_f32_bf16 v58, v69, v51, v58
  v_dot2_f32_bf16 v59, v73, v55, v59
  v_dot2_f32_bf16 v58, v66, v48, v58
  v_dot2_f32_bf16 v59, v70, v52, v59
  v_dot2_f32_bf16 v58, v74, v56, v58
  v_dot2_f32_bf16 v59, v67, v49, v59
  v_dot2_f32_bf16 v58, v71, v53, v58
  v_dot2_f32_bf16 v59, v75, v57, v59
  s_nop 2
  v_add_f32 v58, v58, v59
  s_nop 1
  v_add_f32_dpp v58, v58, v58 quad_perm:[1,0,3,2] row_mask:0xf bank_mask:0xf
  s_nop 1
  v_add_f32_dpp v58, v58, v58 quad_perm:[2,3,0,1] row_mask:0xf bank_mask:0xf
  s_nop 1
  v_add_f32_dpp v58, v58, v58 row_half_mirror row_mask:0xf bank_mask:0xf
  v_mov_b32 v39, v58
  s_lshr_b32 s46, s42, 1
  s_lshl_b32 s46, s46, 4
  s_and_b32 s47, s42, 1
  s_add_u32 s48, s46, s47
  s_add_u32 s48, s48, s43
  s_and_b32 s48, s48, 511
  s_mul_i32 s48, s48, 3072
  s_add_u32 s42, s42, 1
  s_and_b32 s42, s42, 63
  s_waitcnt vmcnt(0)
  buffer_load_dwordx4 v[88:91], v2, s[4:7], s48 offen offset:0 nt
  buffer_load_dwordx4 v[92:95], v2, s[4:7], s48 offen offset:128 nt
  buffer_load_dwordx4 v[96:99], v2, s[4:7], s48 offen offset:256 nt
  v_dot2_f32_bf16 v58, v76, v46, 0
  v_dot2_f32_bf16 v59, v80, v50, 0
  v_dot2_f32_bf16 v58, v84, v54, v58
  v_dot2_f32_bf16 v59, v77, v47, v59
  v_dot2_f32_bf16 v58, v81, v51, v58
  v_dot2_f32_bf16 v59, v85, v55, v59
  v_dot2_f32_bf16 v58, v78, v48, v58
  v_dot2_f32_bf16 v59, v82, v52, v59
  v_dot2_f32_bf16 v58, v86, v56, v58
  v_dot2_f32_bf16 v59, v79, v49, v59
  v_dot2_f32_bf16 v58, v83, v53, v58
  v_dot2_f32_bf16 v59, v87, v57, v59
  s_nop 2
  v_add_f32 v58, v58, v59
  s_nop 1
  v_add_f32_dpp v58, v58, v58 quad_perm:[1,0,3,2] row_mask:0xf bank_mask:0xf
  s_nop 1
  v_add_f32_dpp v58, v58, v58 quad_perm:[2,3,0,1] row_mask:0xf bank_mask:0xf
  s_nop 1
  v_add_f32_dpp v58, v58, v58 row_half_mirror row_mask:0xf bank_mask:0xf
  v_cndmask_b32 v39, v39, v58, s[54:55]
  s_lshr_b32 s46, s42, 1
  s_lshl_b32 s46, s46, 4
  s_and_b32 s47, s42, 1
  s_add_u32 s48, s46, s47
  s_add_u32 s48, s48, s43
  s_and_b32 s48, s48, 511
  s_mul_i32 s48, s48, 3072
  s_add_u32 s42, s42, 1
  s_and_b32 s42, s42, 63
  s_waitcnt vmcnt(0)
  buffer_load_dwordx4 v[100:103], v2, s[4:7], s48 offen offset:0 nt
  buffer_load_dwordx4 v[104:107], v2, s[4:7], s48 offen offset:128 nt
  buffer_load_dwordx4 v[108:111], v2, s[4:7], s48 offen offset:256 nt
  v_dot2_f32_bf16 v58, v88, v46, 0
  v_dot2_f32_bf16 v59, v92, v50, 0
  v_dot2_f32_bf16 v58, v96, v54, v58
  v_dot2_f32_bf16 v59, v89, v47, v59
  v_dot2_f32_bf16 v58, v93, v51, v58
  v_dot2_f32_bf16 v59, v97, v55, v59
  v_dot2_f32_bf16 v58, v90, v48, v58
  v_dot2_f32_bf16 v59, v94, v52, v59
  v_dot2_f32_bf16 v58, v98, v56, v58
  v_dot2_f32_bf16 v59, v91, v49, v59
  v_dot2_f32_bf16 v58, v95, v53, v58
  v_dot2_f32_bf16 v59, v99, v57, v59
  s_nop 2
  v_add_f32 v58, v58, v59
  s_nop 1
  v_add_f32_dpp v58, v58, v58 quad_perm:[1,0,3,2] row_mask:0xf bank_mask:0xf
  s_nop 1
  v_add_f32_dpp v58, v58, v58 quad_perm:[2,3,0,1] row_mask:0xf bank_mask:0xf
  s_nop 1
  v_add_f32_dpp v58, v58, v58 row_half_mirror row_mask:0xf bank_mask:0xf
  v_cndmask_b32 v39, v39, v58, s[56:57]
  s_lshr_b32 s46, s42, 1
  s_lshl_b32 s46, s46, 4
  s_and_b32 s47, s42, 1
  s_add_u32 s48, s46, s47
  s_add_u32 s48, s48, s43
  s_and_b32 s48, s48, 511
  s_mul_i32 s48, s48, 3072
  s_add_u32 s42, s42, 1
  s_and_b32 s42, s42, 63
  s_waitcnt vmcnt(0)
  buffer_load_dwordx4 v[64:67], v2, s[4:7], s48 offen offset:0 nt
  buffer_load_dwordx4 v[68:71], v2, s[4:7], s48 offen offset:128 nt
  buffer_load_dwordx4 v[72:75], v2, s[4:7], s48 offen offset:256 nt
  v_dot2_f32_bf16 v58, v100, v46, 0
  v_dot2_f32_bf16 v59, v104, v50, 0
  v_dot2_f32_bf16 v58, v108, v54, v58
  v_dot2_f32_bf16 v59, v101, v47, v59
  v_dot2_f32_bf16 v58, v105, v51, v58
  v_dot2_f32_bf16 v59, v109, v55, v59
  v_dot2_f32_bf16 v58, v102, v48, v58
  v_dot2_f32_bf16 v59, v106, v52, v59
  v_dot2_f32_bf16 v58, v110, v56, v58
  v_dot2_f32_bf16 v59, v103, v49, v59
  v_dot2_f32_bf16 v58, v107, v53, v58
  v_dot2_f32_bf16 v59, v111, v57, v59
  s_nop 2
  v_add_f32 v58, v58, v59
  s_nop 1
  v_add_f32_dpp v58, v58, v58 quad_perm:[1,0,3,2] row_mask:0xf bank_mask:0xf
  s_nop 1
  v_add_f32_dpp v58, v58, v58 quad_perm:[2,3,0,1] row_mask:0xf bank_mask:0xf
  s_nop 1
  v_add_f32_dpp v58, v58, v58 row_half_mirror row_mask:0xf bank_mask:0xf
  v_cndmask_b32 v39, v39, v58, s[58:59]
  s_lshr_b32 s46, s42, 1
  s_lshl_b32 s46, s46, 4
  s_and_b32 s47, s42, 1
  s_add_u32 s48, s46, s47
  s_add_u32 s48, s48, s43
  s_and_b32 s48, s48, 511
  s_mul_i32 s48, s48, 3072
  s_add_u32 s42, s42, 1
  s_and_b32 s42, s42, 63
  s_waitcnt vmcnt(0)
  buffer_load_dwordx4 v[76:79], v2, s[4:7], s48 offen offset:0 nt
  buffer_load_dwordx4 v[80:83], v2, s[4:7], s48 offen offset:128 nt
  buffer_load_dwordx4 v[84:87], v2, s[4:7], s48 offen offset:256 nt
  v_dot2_f32_bf16 v58, v64, v46, 0
  v_dot2_f32_bf16 v59, v68, v50, 0
  v_dot2_f32_bf16 v58, v72, v54, v58
  v_dot2_f32_bf16 v59, v65, v47, v59
  v_dot2_f32_bf16 v58, v69, v51, v58
  v_dot2_f32_bf16 v59, v73, v55, v59
  v_dot2_f32_bf16 v58, v66, v48, v58
  v_dot2_f32_bf16 v59, v70, v52, v59
  v_dot2_f32_bf16 v58, v74, v56, v58
  v_dot2_f32_bf16 v59, v67, v49, v59
  v_dot2_f32_bf16 v58, v71, v53, v58
  v_dot2_f32_bf16 v59, v75, v57, v59
  s_nop 2
  v_add_f32 v58, v58, v59
  s_nop 1
  v_add_f32_dpp v58, v58, v58 quad_perm:[1,0,3,2] row_mask:0xf bank_mask:0xf
  s_nop 1
  v_add_f32_dpp v58, v58, v58 quad_perm:[2,3,0,1] row_mask:0xf bank_mask:0xf
  s_nop 1
  v_add_f32_dpp v58, v58, v58 row_half_mirror row_mask:0xf bank_mask:0xf
  v_cndmask_b32 v39, v39, v58, s[60:61]
  s_lshr_b32 s46, s42, 1
  s_lshl_b32 s46, s46, 4
  s_and_b32 s47, s42, 1
  s_add_u32 s48, s46, s47
  s_add_u32 s48, s48, s43
  s_and_b32 s48, s48, 511
  s_mul_i32 s48, s48, 3072
  s_add_u32 s42, s42, 1
  s_and_b32 s42, s42, 63
  s_waitcnt vmcnt(0)
  buffer_load_dwordx4 v[88:91], v2, s[4:7], s48 offen offset:0 nt
  buffer_load_dwordx4 v[92:95], v2, s[4:7], s48 offen offset:128 nt
  buffer_load_dwordx4 v[96:99], v2, s[4:7], s48 offen offset:256 nt
  v_dot2_f32_bf16 v58, v76, v46, 0
  v_dot2_f32_bf16 v59, v80, v50, 0
  v_dot2_f32_bf16 v58, v84, v54, v58
  v_dot2_f32_bf16 v59, v77, v47, v59
  v_dot2_f32_bf16 v58, v81, v51, v58
  v_dot2_f32_bf16 v59, v85, v55, v59
  v_dot2_f32_bf16 v58, v78, v48, v58
  v_dot2_f32_bf16 v59, v82, v52, v59
  v_dot2_f32_bf16 v58, v86, v56, v58
  v_dot2_f32_bf16 v59, v79, v49, v59
  v_dot2_f32_bf16 v58, v83, v53, v58
  v_dot2_f32_bf16 v59, v87, v57, v59
  s_nop 2
  v_add_f32 v58, v58, v59
  s_nop 1
  v_add_f32_dpp v58, v58, v58 quad_perm:[1,0,3,2] row_mask:0xf bank_mask:0xf
  s_nop 1
  v_add_f32_dpp v58, v58, v58 quad_perm:[2,3,0,1] row_mask:0xf bank_mask:0xf
  s_nop 1
  v_add_f32_dpp v58, v58, v58 row_half_mirror row_mask:0xf bank_mask:0xf
  v_cndmask_b32 v39, v39, v58, s[62:63]
  s_lshr_b32 s46, s42, 1
  s_lshl_b32 s46, s46, 4
  s_and_b32 s47, s42, 1
  s_add_u32 s48, s46, s47
  s_add_u32 s48, s48, s43
  s_and_b32 s48, s48, 511
  s_mul_i32 s48, s48, 3072
  s_add_u32 s42, s42, 1
  s_and_b32 s42, s42, 63
  s_waitcnt vmcnt(0)
  buffer_load_dwordx4 v[100:103], v2, s[4:7], s48 offen offset:0 nt
  buffer_load_dwordx4 v[104:107], v2, s[4:7], s48 offen offset:128 nt
  buffer_load_dwordx4 v[108:111], v2, s[4:7], s48 offen offset:256 nt
  v_dot2_f32_bf16 v58, v88, v46, 0
  v_dot2_f32_bf16 v59, v92, v50, 0
  v_dot2_f32_bf16 v58, v96, v54, v58
  v_dot2_f32_bf16 v59, v89, v47, v59
  v_dot2_f32_bf16 v58, v93, v51, v58
  v_dot2_f32_bf16 v59, v97, v55, v59
  v_dot2_f32_bf16 v58, v90, v48, v58
  v_dot2_f32_bf16 v59, v94, v52, v59
  v_dot2_f32_bf16 v58, v98, v56, v58
  v_dot2_f32_bf16 v59, v91, v49, v59
  v_dot2_f32_bf16 v58, v95, v53, v58
  v_dot2_f32_bf16 v59, v99, v57, v59
  s_nop 2
  v_add_f32 v58, v58, v59
  s_nop 1
  v_add_f32_dpp v58, v58, v58 quad_perm:[1,0,3,2] row_mask:0xf bank_mask:0xf
  s_nop 1
  v_add_f32_dpp v58, v58, v58 quad_perm:[2,3,0,1] row_mask:0xf bank_mask:0xf
  s_nop 1
  v_add_f32_dpp v58, v58, v58 row_half_mirror row_mask:0xf bank_mask:0xf
  v_cndmask_b32 v39, v39, v58, s[64:65]
  s_lshr_b32 s46, s42, 1
  s_lshl_b32 s46, s46, 4
  s_and_b32 s47, s42, 1
  s_add_u32 s48, s46, s47
  s_add_u32 s48, s48, s43
  s_and_b32 s48, s48, 511
  s_mul_i32 s48, s48, 3072
  s_add_u32 s42, s42, 1
  s_and_b32 s42, s42, 63
  s_waitcnt vmcnt(0)
  buffer_load_dwordx4 v[64:67], v2, s[4:7], s48 offen offset:0 nt
  buffer_load_dwordx4 v[68:71], v2, s[4:7], s48 offen offset:128 nt
  buffer_load_dwordx4 v[72:75], v2, s[4:7], s48 offen offset:256 nt
  v_dot2_f32_bf16 v58, v100, v46, 0
  v_dot2_f32_bf16 v59, v104, v50, 0
  v_dot2_f32_bf16 v58, v108, v54, v58
  v_dot2_f32_bf16 v59, v101, v47, v59
  v_dot2_f32_bf16 v58, v105, v51, v58
  v_dot2_f32_bf16 v59, v109, v55, v59
  v_dot2_f32_bf16 v58, v102, v48, v58
  v_dot2_f32_bf16 v59, v106, v52, v59
  v_dot2_f32_bf16 v58, v110, v56, v58
  v_dot2_f32_bf16 v59, v103, v49, v59
  v_dot2_f32_bf16 v58, v107, v53, v58
  v_dot2_f32_bf16 v59, v111, v57, v59
  s_nop 2
  v_add_f32 v58, v58, v59
  s_nop 1
  v_add_f32_dpp v58, v58, v58 quad_perm:[1,0,3,2] row_mask:0xf bank_mask:0xf
  s_nop 1
  v_add_f32_dpp v58, v58, v58 quad_perm:[2,3,0,1] row_mask:0xf bank_mask:0xf
  s_nop 1
  v_add_f32_dpp v58, v58, v58 row_half_mirror row_mask:0xf bank_mask:0xf
  v_cndmask_b32 v39, v39, v58, s[66:67]
  s_lshr_b32 s46, s42, 1
  s_lshl_b32 s46, s46, 4
  s_and_b32 s47, s42, 1
  s_add_u32 s48, s46, s47
  s_add_u32 s48, s48, s43
  s_and_b32 s48, s48, 511
  s_mul_i32 s48, s48, 3072
  s_add_u32 s42, s42, 1
  s_and_b32 s42, s42, 63
  s_waitcnt vmcnt(0)
  buffer_load_dwordx4 v[76:79], v2, s[4:7], s48 offen offset:0 nt
  buffer_load_dwordx4 v[80:83], v2, s[4:7], s48 offen offset:128 nt
  buffer_load_dwordx4 v[84:87], v2, s[4:7], s48 offen offset:256 nt
  v_dot2_f32_bf16 v58, v64, v46, 0
  v_dot2_f32_bf16 v59, v68, v50, 0
  v_dot2_f32_bf16 v58, v72, v54, v58
  v_dot2_f32_bf16 v59, v65, v47, v59
  v_dot2_f32_bf16 v58, v69, v51, v58
  v_dot2_f32_bf16 v59, v73, v55, v59
  v_dot2_f32_bf16 v58, v66, v48, v58
  v_dot2_f32_bf16 v59, v70, v52, v59
  v_dot2_f32_bf16 v58, v74, v56, v58
  v_dot2_f32_bf16 v59, v67, v49, v59
  v_dot2_f32_bf16 v58, v71, v53, v58
  v_dot2_f32_bf16 v59, v75, v57, v59
  s_nop 2
  v_add_f32 v58, v58, v59
  s_nop 1
  v_add_f32_dpp v58, v58, v58 quad_perm:[1,0,3,2] row_mask:0xf bank_mask:0xf
  s_nop 1
  v_add_f32_dpp v58, v58, v58 quad_perm:[2,3,0,1] row_mask:0xf bank_mask:0xf
  s_nop 1
  v_add_f32_dpp v58, v58, v58 row_half_mirror row_mask:0xf bank_mask:0xf
  v_mov_b32 v40, v58
  s_lshr_b32 s46, s42, 1
  s_lshl_b32 s46, s46, 4
  s_and_b32 s47, s42, 1
  s_add_u32 s48, s46, s47
  s_add_u32 s48, s48, s43
  s_and_b32 s48, s48, 511
  s_mul_i32 s48, s48, 3072
  s_add_u32 s42, s42, 1
  s_and_b32 s42, s42, 63
  s_waitcnt vmcnt(0)
  buffer_load_dwordx4 v[88:91], v2, s[4:7], s48 offen offset:0 nt
  buffer_load_dwordx4 v[92:95], v2, s[4:7], s48 offen offset:128 nt
  buffer_load_dwordx4 v[96:99], v2, s[4:7], s48 offen offset:256 nt
  v_dot2_f32_bf16 v58, v76, v46, 0
  v_dot2_f32_bf16 v59, v80, v50, 0
  v_dot2_f32_bf16 v58, v84, v54, v58
  v_dot2_f32_bf16 v59, v77, v47, v59
  v_dot2_f32_bf16 v58, v81, v51, v58
  v_dot2_f32_bf16 v59, v85, v55, v59
  v_dot2_f32_bf16 v58, v78, v48, v58
  v_dot2_f32_bf16 v59, v82, v52, v59
  v_dot2_f32_bf16 v58, v86, v56, v58
  v_dot2_f32_bf16 v59, v79, v49, v59
  v_dot2_f32_bf16 v58, v83, v53, v58
  v_dot2_f32_bf16 v59, v87, v57, v59
  s_nop 2
  v_add_f32 v58, v58, v59
  s_nop 1
  v_add_f32_dpp v58, v58, v58 quad_perm:[1,0,3,2] row_mask:0xf bank_mask:0xf
  s_nop 1
  v_add_f32_dpp v58, v58, v58 quad_perm:[2,3,0,1] row_mask:0xf bank_mask:0xf
  s_nop 1
  v_add_f32_dpp v58, v58, v58 row_half_mirror row_mask:0xf bank_mask:0xf
  v_cndmask_b32 v40, v40, v58, s[54:55]
  s_lshr_b32 s46, s42, 1
  s_lshl_b32 s46, s46, 4
  s_and_b32 s47, s42, 1
  s_add_u32 s48, s46, s47
  s_add_u32 s48, s48, s43
  s_and_b32 s48, s48, 511
  s_mul_i32 s48, s48, 3072
  s_add_u32 s42, s42, 1
  s_and_b32 s42, s42, 63
  s_waitcnt vmcnt(0)
  buffer_load_dwordx4 v[100:103], v2, s[4:7], s48 offen offset:0 nt
  buffer_load_dwordx4 v[104:107], v2, s[4:7], s48 offen offset:128 nt
  buffer_load_dwordx4 v[108:111], v2, s[4:7], s48 offen offset:256 nt
  v_dot2_f32_bf16 v58, v88, v46, 0
  v_dot2_f32_bf16 v59, v92, v50, 0
  v_dot2_f32_bf16 v58, v96, v54, v58
  v_dot2_f32_bf16 v59, v89, v47, v59
  v_dot2_f32_bf16 v58, v93, v51, v58
  v_dot2_f32_bf16 v59, v97, v55, v59
  v_dot2_f32_bf16 v58, v90, v48, v58
  v_dot2_f32_bf16 v59, v94, v52, v59
  v_dot2_f32_bf16 v58, v98, v56, v58
  v_dot2_f32_bf16 v59, v91, v49, v59
  v_dot2_f32_bf16 v58, v95, v53, v58
  v_dot2_f32_bf16 v59, v99, v57, v59
  s_nop 2
  v_add_f32 v58, v58, v59
  s_nop 1
  v_add_f32_dpp v58, v58, v58 quad_perm:[1,0,3,2] row_mask:0xf bank_mask:0xf
  s_nop 1
  v_add_f32_dpp v58, v58, v58 quad_perm:[2,3,0,1] row_mask:0xf bank_mask:0xf
  s_nop 1
  v_add_f32_dpp v58, v58, v58 row_half_mirror row_mask:0xf bank_mask:0xf
  v_cndmask_b32 v40, v40, v58, s[56:57]
  s_lshr_b32 s46, s42, 1
  s_lshl_b32 s46, s46, 4
  s_and_b32 s47, s42, 1
  s_add_u32 s48, s46, s47
  s_add_u32 s48, s48, s43
  s_and_b32 s48, s48, 511
  s_mul_i32 s48, s48, 3072
  s_add_u32 s42, s42, 1
  s_and_b32 s42, s42, 63
  s_waitcnt vmcnt(0)
  buffer_load_dwordx4 v[64:67], v2, s[4:7], s48 offen offset:0 nt
  buffer_load_dwordx4 v[68:71], v2, s[4:7], s48 offen offset:128 nt
  buffer_load_dwordx4 v[72:75], v2, s[4:7], s48 offen offset:256 nt
  v_dot2_f32_bf16 v58, v100, v46, 0
  v_dot2_f32_bf16 v59, v104, v50, 0
  v_dot2_f32_bf16 v58, v108, v54, v58
  v_dot2_f32_bf16 v59, v101, v47, v59
  v_dot2_f32_bf16 v58, v105, v51, v58
  v_dot2_f32_bf16 v59, v109, v55, v59
  v_dot2_f32_bf16 v58, v102, v48, v58
  v_dot2_f32_bf16 v59, v106, v52, v59
  v_dot2_f32_bf16 v58, v110, v56, v58
  v_dot2_f32_bf16 v59, v103, v49, v59
  v_dot2_f32_bf16 v58, v107, v53, v58
  v_dot2_f32_bf16 v59, v111, v57, v59
  s_nop 2
  v_add_f32 v58, v58, v59
  s_nop 1
  v_add_f32_dpp v58, v58, v58 quad_perm:[1,0,3,2] row_mask:0xf bank_mask:0xf
  s_nop 1
  v_add_f32_dpp v58, v58, v58 quad_perm:[2,3,0,1] row_mask:0xf bank_mask:0xf
  s_nop 1
  v_add_f32_dpp v58, v58, v58 row_half_mirror row_mask:0xf bank_mask:0xf
  v_cndmask_b32 v40, v40, v58, s[58:59]
  s_lshr_b32 s46, s42, 1
  s_lshl_b32 s46, s46, 4
  s_and_b32 s47, s42, 1
  s_add_u32 s48, s46, s47
  s_add_u32 s48, s48, s43
  s_and_b32 s48, s48, 511
  s_mul_i32 s48, s48, 3072
  s_add_u32 s42, s42, 1
  s_and_b32 s42, s42, 63
  s_waitcnt vmcnt(0)
  buffer_load_dwordx4 v[76:79], v2, s[4:7], s48 offen offset:0 nt
  buffer_load_dwordx4 v[80:83], v2, s[4:7], s48 offen offset:128 nt
  buffer_load_dwordx4 v[84:87], v2, s[4:7], s48 offen offset:256 nt
  v_dot2_f32_bf16 v58, v64, v46, 0
  v_dot2_f32_bf16 v59, v68, v50, 0
  v_dot2_f32_bf16 v58, v72, v54, v58
  v_dot2_f32_bf16 v59, v65, v47, v59
  v_dot2_f32_bf16 v58, v69, v51, v58
  v_dot2_f32_bf16 v59, v73, v55, v59
  v_dot2_f32_bf16 v58, v66, v48, v58
  v_dot2_f32_bf16 v59, v70, v52, v59
  v_dot2_f32_bf16 v58, v74, v56, v58
  v_dot2_f32_bf16 v59, v67, v49, v59
  v_dot2_f32_bf16 v58, v71, v53, v58
  v_dot2_f32_bf16 v59, v75, v57, v59
  s_nop 2
  v_add_f32 v58, v58, v59
  s_nop 1
  v_add_f32_dpp v58, v58, v58 quad_perm:[1,0,3,2] row_mask:0xf bank_mask:0xf
  s_nop 1
  v_add_f32_dpp v58, v58, v58 quad_perm:[2,3,0,1] row_mask:0xf bank_mask:0xf
  s_nop 1
  v_add_f32_dpp v58, v58, v58 row_half_mirror row_mask:0xf bank_mask:0xf
  v_cndmask_b32 v40, v40, v58, s[60:61]
  s_mul_i32 s51, s3, 245760
  s_mov_b32 s50, s40
  s_mul_i32 s44, s50, 24576
  s_add_u32 s44, s44, s51
  buffer_load_dwordx4 v[112:115], v4, s[20:23], s44 offen
  s_add_u32 s50, s50, 1
  s_cmp_ge_u32 s50, 10
  s_cselect_b32 s47, 10, 0
  s_sub_u32 s50, s50, s47
  s_lshr_b32 s46, s42, 1
  s_lshl_b32 s46, s46, 4
  s_and_b32 s47, s42, 1
  s_add_u32 s48, s46, s47
  s_add_u32 s48, s48, s43
  s_and_b32 s48, s48, 511
  s_mul_i32 s48, s48, 3072
  s_add_u32 s42, s42, 1
  s_and_b32 s42, s42, 63
  s_waitcnt vmcnt(1)
  buffer_load_dwordx4 v[88:91], v2, s[4:7], s48 offen offset:0 nt
  buffer_load_dwordx4 v[92:95], v2, s[4:7], s48 offen offset:128 nt
  buffer_load_dwordx4 v[96:99], v2, s[4:7], s48 offen offset:256 nt
  v_dot2_f32_bf16 v58, v76, v46, 0
  v_dot2_f32_bf16 v59, v80, v50, 0
  v_dot2_f32_bf16 v58, v84, v54, v58
  v_dot2_f32_bf16 v59, v77, v47, v59
  v_dot2_f32_bf16 v58, v81, v51, v58
  v_dot2_f32_bf16 v59, v85, v55, v59
  v_dot2_f32_bf16 v58, v78, v48, v58
  v_dot2_f32_bf16 v59, v82, v52, v59
  v_dot2_f32_bf16 v58, v86, v56, v58
  v_dot2_f32_bf16 v59, v79, v49, v59
  v_dot2_f32_bf16 v58, v83, v53, v58
  v_dot2_f32_bf16 v59, v87, v57, v59
  s_nop 2
  v_add_f32 v58, v58, v59
  s_nop 1
  v_add_f32_dpp v58, v58, v58 quad_perm:[1,0,3,2] row_mask:0xf bank_mask:0xf
  s_nop 1
  v_add_f32_dpp v58, v58, v58 quad_perm:[2,3,0,1] row_mask:0xf bank_mask:0xf
  s_nop 1
  v_add_f32_dpp v58, v58, v58 row_half_mirror row_mask:0xf bank_mask:0xf
  v_cndmask_b32 v40, v40, v58, s[62:63]
  s_mul_i32 s44, s50, 24576
  s_add_u32 s44, s44, s51
  buffer_load_dwordx4 v[116:119], v4, s[20:23], s44 offen
  s_add_u32 s50, s50, 1
  s_cmp_ge_u32 s50, 10
  s_cselect_b32 s47, 10, 0
  s_sub_u32 s50, s50, s47
  s_lshr_b32 s46, s42, 1
  s_lshl_b32 s46, s46, 4
  s_and_b32 s47, s42, 1
  s_add_u32 s48, s46, s47
  s_add_u32 s48, s48, s43
  s_and_b32 s48, s48, 511
  s_mul_i32 s48, s48, 3072
  s_add_u32 s42, s42, 1
  s_and_b32 s42, s42, 63
  s_waitcnt vmcnt(1)
  buffer_load_dwordx4 v[100:103], v2, s[4:7], s48 offen offset:0 nt
  buffer_load_dwordx4 v[104:107], v2, s[4:7], s48 offen offset:128 nt
  buffer_load_dwordx4 v[108:111], v2, s[4:7], s48 offen offset:256 nt
  v_dot2_f32_bf16 v58, v88, v46, 0
  v_dot2_f32_bf16 v59, v92, v50, 0
  v_dot2_f32_bf16 v58, v96, v54, v58
  v_dot2_f32_bf16 v59, v89, v47, v59
  v_dot2_f32_bf16 v58, v93, v51, v58
  v_dot2_f32_bf16 v59, v97, v55, v59
  v_dot2_f32_bf16 v58, v90, v48, v58
  v_dot2_f32_bf16 v59, v94, v52, v59
  v_dot2_f32_bf16 v58, v98, v56, v58
  v_dot2_f32_bf16 v59, v91, v49, v59
  v_dot2_f32_bf16 v58, v95, v53, v58
  v_dot2_f32_bf16 v59, v99, v57, v59
  s_nop 2
  v_add_f32 v58, v58, v59
  s_nop 1
  v_add_f32_dpp v58, v58, v58 quad_perm:[1,0,3,2] row_mask:0xf bank_mask:0xf
  s_nop 1
  v_add_f32_dpp v58, v58, v58 quad_perm:[2,3,0,1] row_mask:0xf bank_mask:0xf
  s_nop 1
  v_add_f32_dpp v58, v58, v58 row_half_mirror row_mask:0xf bank_mask:0xf
  v_cndmask_b32 v40, v40, v58, s[64:65]
  s_mul_i32 s44, s50, 24576
  s_add_u32 s44, s44, s51
  buffer_load_dwordx4 v[120:123], v4, s[20:23], s44 offen
  s_add_u32 s50, s50, 1
  s_cmp_ge_u32 s50, 10
  s_cselect_b32 s47, 10, 0
  s_sub_u32 s50, s50, s47
  s_lshr_b32 s46, s42, 1
  s_lshl_b32 s46, s46, 4
  s_and_b32 s47, s42, 1
  s_add_u32 s48, s46, s47
  s_add_u32 s48, s48, s43
  s_and_b32 s48, s48, 511
  s_mul_i32 s48, s48, 3072
  s_add_u32 s42, s42, 1
  s_and_b32 s42, s42, 63
  s_waitcnt vmcnt(1)
  buffer_load_dwordx4 v[64:67], v2, s[4:7], s48 offen offset:0 nt
  buffer_load_dwordx4 v[68:71], v2, s[4:7], s48 offen offset:128 nt
  buffer_load_dwordx4 v[72:75], v2, s[4:7], s48 offen offset:256 nt
  v_dot2_f32_bf16 v58, v100, v46, 0
  v_dot2_f32_bf16 v59, v104, v50, 0
  v_dot2_f32_bf16 v58, v108, v54, v58
  v_dot2_f32_bf16 v59, v101, v47, v59
  v_dot2_f32_bf16 v58, v105, v51, v58
  v_dot2_f32_bf16 v59, v109, v55, v59
  v_dot2_f32_bf16 v58, v102, v48, v58
  v_dot2_f32_bf16 v59, v106, v52, v59
  v_dot2_f32_bf16 v58, v110, v56, v58
  v_dot2_f32_bf16 v59, v103, v49, v59
  v_dot2_f32_bf16 v58, v107, v53, v58
  v_dot2_f32_bf16 v59, v111, v57, v59
  s_nop 2
  v_add_f32 v58, v58, v59
  s_nop 1
  v_add_f32_dpp v58, v58, v58 quad_perm:[1,0,3,2] row_mask:0xf bank_mask:0xf
  s_nop 1
  v_add_f32_dpp v58, v58, v58 quad_perm:[2,3,0,1] row_mask:0xf bank_mask:0xf
  s_nop 1
  v_add_f32_dpp v58, v58, v58 row_half_mirror row_mask:0xf bank_mask:0xf
  v_cndmask_b32 v40, v40, v58, s[66:67]
  s_mul_i32 s44, s50, 24576
  s_add_u32 s44, s44, s51
  buffer_load_dwordx4 v[124:127], v4, s[20:23], s44 offen
  s_add_u32 s50, s50, 1
  s_cmp_ge_u32 s50, 10
  s_cselect_b32 s47, 10, 0
  s_sub_u32 s50, s50, s47
  s_lshr_b32 s46, s42, 1
  s_lshl_b32 s46, s46, 4
  s_and_b32 s47, s42, 1
  s_add_u32 s48, s46, s47
  s_add_u32 s48, s48, s43
  s_and_b32 s48, s48, 511
  s_mul_i32 s48, s48, 3072
  s_add_u32 s42, s42, 1
  s_and_b32 s42, s42, 63
  s_waitcnt vmcnt(1)
  buffer_load_dwordx4 v[76:79], v2, s[4:7], s48 offen offset:0 nt
  buffer_load_dwordx4 v[80:83], v2, s[4:7], s48 offen offset:128 nt
  buffer_load_dwordx4 v[84:87], v2, s[4:7], s48 offen offset:256 nt
  v_dot2_f32_bf16 v58, v64, v46, 0
  v_dot2_f32_bf16 v59, v68, v50, 0
  v_dot2_f32_bf16 v58, v72, v54, v58
  v_dot2_f32_bf16 v59, v65, v47, v59
  v_dot2_f32_bf16 v58, v69, v51, v58
  v_dot2_f32_bf16 v59, v73, v55, v59
  v_dot2_f32_bf16 v58, v66, v48, v58
  v_dot2_f32_bf16 v59, v70, v52, v59
  v_dot2_f32_bf16 v58, v74, v56, v58
  v_dot2_f32_bf16 v59, v67, v49, v59
  v_dot2_f32_bf16 v58, v71, v53, v58
  v_dot2_f32_bf16 v59, v75, v57, v59
  s_nop 2
  v_add_f32 v58, v58, v59
  s_nop 1
  v_add_f32_dpp v58, v58, v58 quad_perm:[1,0,3,2] row_mask:0xf bank_mask:0xf
  s_nop 1
  v_add_f32_dpp v58, v58, v58 quad_perm:[2,3,0,1] row_mask:0xf bank_mask:0xf
  s_nop 1
  v_add_f32_dpp v58, v58, v58 row_half_mirror row_mask:0xf bank_mask:0xf
  v_mov_b32 v41, v58
  s_mul_i32 s44, s50, 24576
  s_add_u32 s44, s44, s51
  buffer_load_dwordx4 v[128:131], v4, s[20:23], s44 offen
  s_add_u32 s50, s50, 1
  s_cmp_ge_u32 s50, 10
  s_cselect_b32 s47, 10, 0
  s_sub_u32 s50, s50, s47
  s_lshr_b32 s46, s42, 1
  s_lshl_b32 s46, s46, 4
  s_and_b32 s47, s42, 1
  s_add_u32 s48, s46, s47
  s_add_u32 s48, s48, s43
  s_and_b32 s48, s48, 511
  s_mul_i32 s48, s48, 3072
  s_add_u32 s42, s42, 1
  s_and_b32 s42, s42, 63
  s_waitcnt vmcnt(1)
  buffer_load_dwordx4 v[88:91], v2, s[4:7], s48 offen offset:0 nt
  buffer_load_dwordx4 v[92:95], v2, s[4:7], s48 offen offset:128 nt
  buffer_load_dwordx4 v[96:99], v2, s[4:7], s48 offen offset:256 nt
  v_dot2_f32_bf16 v58, v76, v46, 0
  v_dot2_f32_bf16 v59, v80, v50, 0
  v_dot2_f32_bf16 v58, v84, v54, v58
  v_dot2_f32_bf16 v59, v77, v47, v59
  v_dot2_f32_bf16 v58, v81, v51, v58
  v_dot2_f32_bf16 v59, v85, v55, v59
  v_dot2_f32_bf16 v58, v78, v48, v58
  v_dot2_f32_bf16 v59, v82, v52, v59
  v_dot2_f32_bf16 v58, v86, v56, v58
  v_dot2_f32_bf16 v59, v79, v49, v59
  v_dot2_f32_bf16 v58, v83, v53, v58
  v_dot2_f32_bf16 v59, v87, v57, v59
  s_nop 2
  v_add_f32 v58, v58, v59
  s_nop 1
  v_add_f32_dpp v58, v58, v58 quad_perm:[1,0,3,2] row_mask:0xf bank_mask:0xf
  s_nop 1
  v_add_f32_dpp v58, v58, v58 quad_perm:[2,3,0,1] row_mask:0xf bank_mask:0xf
  s_nop 1
  v_add_f32_dpp v58, v58, v58 row_half_mirror row_mask:0xf bank_mask:0xf
  v_cndmask_b32 v41, v41, v58, s[54:55]
  s_mul_i32 s44, s50, 24576
  s_add_u32 s44, s44, s51
  buffer_load_dwordx4 v[132:135], v4, s[20:23], s44 offen
  s_add_u32 s50, s50, 1
  s_cmp_ge_u32 s50, 10
  s_cselect_b32 s47, 10, 0
  s_sub_u32 s50, s50, s47
  s_lshr_b32 s46, s42, 1
  s_lshl_b32 s46, s46, 4
  s_and_b32 s47, s42, 1
  s_add_u32 s48, s46, s47
  s_add_u32 s48, s48, s43
  s_and_b32 s48, s48, 511
  s_mul_i32 s48, s48, 3072
  s_add_u32 s42, s42, 1
  s_and_b32 s42, s42, 63
  s_waitcnt vmcnt(1)
  buffer_load_dwordx4 v[100:103], v2, s[4:7], s48 offen offset:0 nt
  buffer_load_dwordx4 v[104:107], v2, s[4:7], s48 offen offset:128 nt
  buffer_load_dwordx4 v[108:111], v2, s[4:7], s48 offen offset:256 nt
  v_dot2_f32_bf16 v58, v88, v46, 0
  v_dot2_f32_bf16 v59, v92, v50, 0
  v_dot2_f32_bf16 v58, v96, v54, v58
  v_dot2_f32_bf16 v59, v89, v47, v59
  v_dot2_f32_bf16 v58, v93, v51, v58
  v_dot2_f32_bf16 v59, v97, v55, v59
  v_dot2_f32_bf16 v58, v90, v48, v58
  v_dot2_f32_bf16 v59, v94, v52, v59
  v_dot2_f32_bf16 v58, v98, v56, v58
  v_dot2_f32_bf16 v59, v91, v49, v59
  v_dot2_f32_bf16 v58, v95, v53, v58
  v_dot2_f32_bf16 v59, v99, v57, v59
  s_nop 2
  v_add_f32 v58, v58, v59
  s_nop 1
  v_add_f32_dpp v58, v58, v58 quad_perm:[1,0,3,2] row_mask:0xf bank_mask:0xf
  s_nop 1
  v_add_f32_dpp v58, v58, v58 quad_perm:[2,3,0,1] row_mask:0xf bank_mask:0xf
  s_nop 1
  v_add_f32_dpp v58, v58, v58 row_half_mirror row_mask:0xf bank_mask:0xf
  v_cndmask_b32 v41, v41, v58, s[56:57]
  s_mul_i32 s44, s50, 24576
  s_add_u32 s44, s44, s51
  buffer_load_dwordx4 v[136:139], v4, s[20:23], s44 offen
  s_add_u32 s50, s50, 1
  s_cmp_ge_u32 s50, 10
  s_cselect_b32 s47, 10, 0
  s_sub_u32 s50, s50, s47
  s_lshr_b32 s46, s42, 1
  s_lshl_b32 s46, s46, 4
  s_and_b32 s47, s42, 1
  s_add_u32 s48, s46, s47
  s_add_u32 s48, s48, s43
  s_and_b32 s48, s48, 511
  s_mul_i32 s48, s48, 3072
  s_add_u32 s42, s42, 1
  s_and_b32 s42, s42, 63
  s_waitcnt vmcnt(1)
  buffer_load_dwordx4 v[64:67], v2, s[4:7], s48 offen offset:0 nt
  buffer_load_dwordx4 v[68:71], v2, s[4:7], s48 offen offset:128 nt
  buffer_load_dwordx4 v[72:75], v2, s[4:7], s48 offen offset:256 nt
  v_dot2_f32_bf16 v58, v100, v46, 0
  v_dot2_f32_bf16 v59, v104, v50, 0
  v_dot2_f32_bf16 v58, v108, v54, v58
  v_dot2_f32_bf16 v59, v101, v47, v59
  v_dot2_f32_bf16 v58, v105, v51, v58
  v_dot2_f32_bf16 v59, v109, v55, v59
  v_dot2_f32_bf16 v58, v102, v48, v58
  v_dot2_f32_bf16 v59, v106, v52, v59
  v_dot2_f32_bf16 v58, v110, v56, v58
  v_dot2_f32_bf16 v59, v103, v49, v59
  v_dot2_f32_bf16 v58, v107, v53, v58
  v_dot2_f32_bf16 v59, v111, v57, v59
  s_nop 2
  v_add_f32 v58, v58, v59
  s_nop 1
  v_add_f32_dpp v58, v58, v58 quad_perm:[1,0,3,2] row_mask:0xf bank_mask:0xf
  s_nop 1
  v_add_f32_dpp v58, v58, v58 quad_perm:[2,3,0,1] row_mask:0xf bank_mask:0xf
  s_nop 1
  v_add_f32_dpp v58, v58, v58 row_half_mirror row_mask:0xf bank_mask:0xf
  v_cndmask_b32 v41, v41, v58, s[58:59]
  s_mul_i32 s44, s50, 24576
  s_add_u32 s44, s44, s51
  buffer_load_dwordx4 v[140:143], v4, s[20:23], s44 offen
  s_add_u32 s50, s50, 1
  s_cmp_ge_u32 s50, 10
  s_cselect_b32 s47, 10, 0
  s_sub_u32 s50, s50, s47
  s_lshr_b32 s46, s42, 1
  s_lshl_b32 s46, s46, 4
  s_and_b32 s47, s42, 1
  s_add_u32 s48, s46, s47
  s_add_u32 s48, s48, s43
  s_and_b32 s48, s48, 511
  s_mul_i32 s48, s48, 3072
  s_add_u32 s42, s42, 1
  s_and_b32 s42, s42, 63
  s_waitcnt vmcnt(1)
  buffer_load_dwordx4 v[76:79], v2, s[4:7], s48 offen offset:0 nt
  buffer_load_dwordx4 v[80:83], v2, s[4:7], s48 offen offset:128 nt
  buffer_load_dwordx4 v[84:87], v2, s[4:7], s48 offen offset:256 nt
  v_dot2_f32_bf16 v58, v64, v46, 0
  v_dot2_f32_bf16 v59, v68, v50, 0
  v_dot2_f32_bf16 v58, v72, v54, v58
  v_dot2_f32_bf16 v59, v65, v47, v59
  v_dot2_f32_bf16 v58, v69, v51, v58
  v_dot2_f32_bf16 v59, v73, v55, v59
  v_dot2_f32_bf16 v58, v66, v48, v58
  v_dot2_f32_bf16 v59, v70, v52, v59
  v_dot2_f32_bf16 v58, v74, v56, v58
  v_dot2_f32_bf16 v59, v67, v49, v59
  v_dot2_f32_bf16 v58, v71, v53, v58
  v_dot2_f32_bf16 v59, v75, v57, v59
  s_nop 2
  v_add_f32 v58, v58, v59
  s_nop 1
  v_add_f32_dpp v58, v58, v58 quad_perm:[1,0,3,2] row_mask:0xf bank_mask:0xf
  s_nop 1
  v_add_f32_dpp v58, v58, v58 quad_perm:[2,3,0,1] row_mask:0xf bank_mask:0xf
  s_nop 1
  v_add_f32_dpp v58, v58, v58 row_half_mirror row_mask:0xf bank_mask:0xf
  v_cndmask_b32 v41, v41, v58, s[60:61]
  s_mul_i32 s44, s50, 24576
  s_add_u32 s44, s44, s51
  buffer_load_dwordx4 v[144:147], v4, s[20:23], s44 offen
  s_add_u32 s50, s50, 1
  s_cmp_ge_u32 s50, 10
  s_cselect_b32 s47, 10, 0
  s_sub_u32 s50, s50, s47
  s_lshr_b32 s46, s42, 1
  s_lshl_b32 s46, s46, 4
  s_and_b32 s47, s42, 1
  s_add_u32 s48, s46, s47
  s_add_u32 s48, s48, s43
  s_and_b32 s48, s48, 511
  s_mul_i32 s48, s48, 3072
  s_add_u32 s42, s42, 1
  s_and_b32 s42, s42, 63
  s_waitcnt vmcnt(1)
  buffer_load_dwordx4 v[88:91], v2, s[4:7], s48 offen offset:0 nt
  buffer_load_dwordx4 v[92:95], v2, s[4:7], s48 offen offset:128 nt
  buffer_load_dwordx4 v[96:99], v2, s[4:7], s48 offen offset:256 nt
  v_dot2_f32_bf16 v58, v76, v46, 0
  v_dot2_f32_bf16 v59, v80, v50, 0
  v_dot2_f32_bf16 v58, v84, v54, v58
  v_dot2_f32_bf16 v59, v77, v47, v59
  v_dot2_f32_bf16 v58, v81, v51, v58
  v_dot2_f32_bf16 v59, v85, v55, v59
  v_dot2_f32_bf16 v58, v78, v48, v58
  v_dot2_f32_bf16 v59, v82, v52, v59
  v_dot2_f32_bf16 v58, v86, v56, v58
  v_dot2_f32_bf16 v59, v79, v49, v59
  v_dot2_f32_bf16 v58, v83, v53, v58
  v_dot2_f32_bf16 v59, v87, v57, v59
  s_nop 2
  v_add_f32 v58, v58, v59
  s_nop 1
  v_add_f32_dpp v58, v58, v58 quad_perm:[1,0,3,2] row_mask:0xf bank_mask:0xf
  s_nop 1
  v_add_f32_dpp v58, v58, v58 quad_perm:[2,3,0,1] row_mask:0xf bank_mask:0xf
  s_nop 1
  v_add_f32_dpp v58, v58, v58 row_half_mirror row_mask:0xf bank_mask:0xf
  v_cndmask_b32 v41, v41, v58, s[62:63]
  s_mul_i32 s44, s50, 24576
  s_add_u32 s44, s44, s51
  buffer_load_dwordx4 v[148:151], v4, s[20:23], s44 offen
  s_add_u32 s50, s50, 1
  s_cmp_ge_u32 s50, 10
  s_cselect_b32 s47, 10, 0
  s_sub_u32 s50, s50, s47
  s_lshr_b32 s46, s42, 1
  s_lshl_b32 s46, s46, 4
  s_and_b32 s47, s42, 1
  s_add_u32 s48, s46, s47
  s_add_u32 s48, s48, s43
  s_and_b32 s48, s48, 511
  s_mul_i32 s48, s48, 3072
  s_add_u32 s42, s42, 1
  s_and_b32 s42, s42, 63
  s_waitcnt vmcnt(1)
  buffer_load_dwordx4 v[100:103], v2, s[4:7], s48 offen offset:0 nt
  buffer_load_dwordx4 v[104:107], v2, s[4:7], s48 offen offset:128 nt
  buffer_load_dwordx4 v[108:111], v2, s[4:7], s48 offen offset:256 nt
  v_dot2_f32_bf16 v58, v88, v46, 0
  v_dot2_f32_bf16 v59, v92, v50, 0
  v_dot2_f32_bf16 v58, v96, v54, v58
  v_dot2_f32_bf16 v59, v89, v47, v59
  v_dot2_f32_bf16 v58, v93, v51, v58
  v_dot2_f32_bf16 v59, v97, v55, v59
  v_dot2_f32_bf16 v58, v90, v48, v58
  v_dot2_f32_bf16 v59, v94, v52, v59
  v_dot2_f32_bf16 v58, v98, v56, v58
  v_dot2_f32_bf16 v59, v91, v49, v59
  v_dot2_f32_bf16 v58, v95, v53, v58
  v_dot2_f32_bf16 v59, v99, v57, v59
  s_nop 2
  v_add_f32 v58, v58, v59
  s_nop 1
  v_add_f32_dpp v58, v58, v58 quad_perm:[1,0,3,2] row_mask:0xf bank_mask:0xf
  s_nop 1
  v_add_f32_dpp v58, v58, v58 quad_perm:[2,3,0,1] row_mask:0xf bank_mask:0xf
  s_nop 1
  v_add_f32_dpp v58, v58, v58 row_half_mirror row_mask:0xf bank_mask:0xf
  v_cndmask_b32 v41, v41, v58, s[64:65]
  s_lshr_b32 s46, s42, 1
  s_lshl_b32 s46, s46, 4
  s_and_b32 s47, s42, 1
  s_add_u32 s48, s46, s47
  s_add_u32 s48, s48, s43
  s_and_b32 s48, s48, 511
  s_mul_i32 s48, s48, 3072
  s_add_u32 s42, s42, 1
  s_and_b32 s42, s42, 63
  s_waitcnt vmcnt(0)
  buffer_load_dwordx4 v[64:67], v2, s[4:7], s48 offen offset:0 nt
  buffer_load_dwordx4 v[68:71], v2, s[4:7], s48 offen offset:128 nt
  buffer_load_dwordx4 v[72:75], v2, s[4:7], s48 offen offset:256 nt
  v_dot2_f32_bf16 v58, v100, v46, 0
  v_dot2_f32_bf16 v59, v104, v50, 0
  v_dot2_f32_bf16 v58, v108, v54, v58
  v_dot2_f32_bf16 v59, v101, v47, v59
  v_dot2_f32_bf16 v58, v105, v51, v58
  v_dot2_f32_bf16 v59, v109, v55, v59
  v_dot2_f32_bf16 v58, v102, v48, v58
  v_dot2_f32_bf16 v59, v106, v52, v59
  v_dot2_f32_bf16 v58, v110, v56, v58
  v_dot2_f32_bf16 v59, v103, v49, v59
  v_dot2_f32_bf16 v58, v107, v53, v58
  v_dot2_f32_bf16 v59, v111, v57, v59
  s_nop 2
  v_add_f32 v58, v58, v59
  s_nop 1
  v_add_f32_dpp v58, v58, v58 quad_perm:[1,0,3,2] row_mask:0xf bank_mask:0xf
  s_nop 1
  v_add_f32_dpp v58, v58, v58 quad_perm:[2,3,0,1] row_mask:0xf bank_mask:0xf
  s_nop 1
  v_add_f32_dpp v58, v58, v58 row_half_mirror row_mask:0xf bank_mask:0xf
  v_cndmask_b32 v41, v41, v58, s[66:67]
  v_and_b32 v14, v232, v6
  v_and_b32 v15, v232, v7
  v_and_b32 v16, v232, v8
  v_and_b32 v17, v232, v9
  s_nop 1
  v_mfma_f32_16x16x32_bf16 v[34:37], v[14:17], v[112:115], 0
  v_and_b32 v18, v233, v6
  v_and_b32 v19, v233, v7
  v_and_b32 v20, v233, v8
  v_and_b32 v21, v233, v9
  s_nop 1
  v_mfma_f32_16x16x32_bf16 v[34:37], v[18:21], v[116:119], v[34:37]
  v_and_b32 v14, v234, v6
  v_and_b32 v15, v234, v7
  v_and_b32 v16, v234, v8
  v_and_b32 v17, v234, v9
  s_nop 1
  v_mfma_f32_16x16x32_bf16 v[34:37], v[14:17], v[120:123], v[34:37]
  v_and_b32 v18, v235, v6
  v_and_b32 v19, v235, v7
  v_and_b32 v20, v235, v8
  v_and_b32 v21, v235, v9
  s_nop 1
  v_mfma_f32_16x16x32_bf16 v[34:37], v[18:21], v[124:127], v[34:37]
  v_and_b32 v14, v236, v6
  v_and_b32 v15, v236, v7
  v_and_b32 v16, v236, v8
  v_and_b32 v17, v236, v9
  s_nop 1
  v_mfma_f32_16x16x32_bf16 v[34:37], v[14:17], v[128:131], v[34:37]
  v_and_b32 v18, v237, v6
  v_and_b32 v19, v237, v7
  v_and_b32 v20, v237, v8
  v_and_b32 v21, v237, v9
  s_nop 1
  v_mfma_f32_16x16x32_bf16 v[34:37], v[18:21], v[132:135], v[34:37]
  v_and_b32 v14, v238, v6
  v_and_b32 v15, v238, v7
  v_and_b32 v16, v238, v8
  v_and_b32 v17, v238, v9
  s_nop 1
  v_mfma_f32_16x16x32_bf16 v[34:37], v[14:17], v[136:139], v[34:37]
  v_and_b32 v18, v239, v6
  v_and_b32 v19, v239, v7
  v_and_b32 v20, v239, v8
  v_and_b32 v21, v239, v9
  s_nop 1
  v_mfma_f32_16x16x32_bf16 v[34:37], v[18:21], v[140:143], v[34:37]
  v_and_b32 v14, v240, v6
  v_and_b32 v15, v240, v7
  v_and_b32 v16, v240, v8
  v_and_b32 v17, v240, v9
  s_nop 1
  v_mfma_f32_16x16x32_bf16 v[34:37], v[14:17], v[144:147], v[34:37]
  v_and_b32 v18, v241, v6
  v_and_b32 v19, v241, v7
  v_and_b32 v20, v241, v8
  v_and_b32 v21, v241, v9
  s_nop 1
  v_mfma_f32_16x16x32_bf16 v[34:37], v[18:21], v[148:151], v[34:37]
  s_mul_i32 s44, s3, 10240
  s_add_u32 s45, s44, 5120
  v_lshrrev_b32 v58, 5, v1
  s_lshl_b32 s44, s3, 1
  v_add_u32 v58, s44, v58
  v_lshlrev_b32 v58, 8, v58
  v_and_b32 v59, 7, v1
  v_lshlrev_b32 v59, 5, v59
  v_add_u32 v58, v58, v59
  v_and_b32 v59, 16, v1
  v_add_u32 v58, v58, v59
  s_mov_b32 exec_lo, 0x00ff00ff
  s_mov_b32 exec_hi, 0xff00ff00
  ds_write_b128 v58, v[34:37] offset:2560
  s_mov_b64 exec, -1
  s_waitcnt lgkmcnt(0)
  s_lshr_b32 s46, s42, 1
  s_lshl_b32 s46, s46, 4
  s_and_b32 s47, s42, 1
  s_add_u32 s48, s46, s47
  s_add_u32 s48, s48, s43
  s_and_b32 s48, s48, 511
  s_mul_i32 s48, s48, 3072
  s_add_u32 s42, s42, 1
  s_and_b32 s42, s42, 63
  s_waitcnt vmcnt(0)
  buffer_load_dwordx4 v[76:79], v2, s[4:7], s48 offen offset:0 nt
  buffer_load_dwordx4 v[80:83], v2, s[4:7], s48 offen offset:128 nt
  buffer_load_dwordx4 v[84:87], v2, s[4:7], s48 offen offset:256 nt
  v_dot2_f32_bf16 v58, v64, v46, 0
  v_dot2_f32_bf16 v59, v68, v50, 0
  v_dot2_f32_bf16 v58, v72, v54, v58
  v_dot2_f32_bf16 v59, v65, v47, v59
  v_dot2_f32_bf16 v58, v69, v51, v58
  v_dot2_f32_bf16 v59, v73, v55, v59
  v_dot2_f32_bf16 v58, v66, v48, v58
  v_dot2_f32_bf16 v59, v70, v52, v59
  v_dot2_f32_bf16 v58, v74, v56, v58
  v_dot2_f32_bf16 v59, v67, v49, v59
  v_dot2_f32_bf16 v58, v71, v53, v58
  v_dot2_f32_bf16 v59, v75, v57, v59
  s_nop 2
  v_add_f32 v58, v58, v59
  s_nop 1
  v_add_f32_dpp v58, v58, v58 quad_perm:[1,0,3,2] row_mask:0xf bank_mask:0xf
  s_nop 1
  v_add_f32_dpp v58, v58, v58 quad_perm:[2,3,0,1] row_mask:0xf bank_mask:0xf
  s_nop 1
  v_add_f32_dpp v58, v58, v58 row_half_mirror row_mask:0xf bank_mask:0xf
  v_mov_b32 v42, v58
  s_mul_i32 s44, s3, 10240
  buffer_load_dwordx4 v[152:155], v5, s[24:27], s44 offen offset:0
  s_barrier
  v_and_b32 v58, 7, v1
  v_lshlrev_b32 v58, 9, v58
  v_lshrrev_b32 v59, 3, v1
  v_lshlrev_b32 v59, 2, v59
  v_add_u32 v58, v58, v59
  s_mul_i32 s44, s3, 32
  v_add_u32 v58, s44, v58
  ds_read2st64_b32 v[60:61], v58 offset0:10 offset1:11
  s_lshr_b32 s46, s42, 1
  s_lshl_b32 s46, s46, 4
  s_and_b32 s47, s42, 1
  s_add_u32 s48, s46, s47
  s_add_u32 s48, s48, s43
  s_and_b32 s48, s48, 511
  s_mul_i32 s48, s48, 3072
  s_add_u32 s42, s42, 1
  s_and_b32 s42, s42, 63
  s_waitcnt vmcnt(1)
  buffer_load_dwordx4 v[88:91], v2, s[4:7], s48 offen offset:0 nt
  buffer_load_dwordx4 v[92:95], v2, s[4:7], s48 offen offset:128 nt
  buffer_load_dwordx4 v[96:99], v2, s[4:7], s48 offen offset:256 nt
  v_dot2_f32_bf16 v58, v76, v46, 0
  v_dot2_f32_bf16 v59, v80, v50, 0
  v_dot2_f32_bf16 v58, v84, v54, v58
  v_dot2_f32_bf16 v59, v77, v47, v59
  v_dot2_f32_bf16 v58, v81, v51, v58
  v_dot2_f32_bf16 v59, v85, v55, v59
  v_dot2_f32_bf16 v58, v78, v48, v58
  v_dot2_f32_bf16 v59, v82, v52, v59
  v_dot2_f32_bf16 v58, v86, v56, v58
  v_dot2_f32_bf16 v59, v79, v49, v59
  v_dot2_f32_bf16 v58, v83, v53, v58
  v_dot2_f32_bf16 v59, v87, v57, v59
  s_nop 2
  v_add_f32 v58, v58, v59
  s_nop 1
  v_add_f32_dpp v58, v58, v58 quad_perm:[1,0,3,2] row_mask:0xf bank_mask:0xf
  s_nop 1
  v_add_f32_dpp v58, v58, v58 quad_perm:[2,3,0,1] row_mask:0xf bank_mask:0xf
  s_nop 1
  v_add_f32_dpp v58, v58, v58 row_half_mirror row_mask:0xf bank_mask:0xf
  v_cndmask_b32 v42, v42, v58, s[54:55]
  s_mul_i32 s44, s3, 10240
  buffer_load_dwordx4 v[156:159], v5, s[24:27], s44 offen offset:256
  s_waitcnt lgkmcnt(0)
  v_add_f32 v60, v60, v61
  s_nop 1
  v_add_f32_dpp v60, v60, v60 quad_perm:[1,0,3,2] row_mask:0xf bank_mask:0xf
  s_nop 1
  v_add_f32_dpp v60, v60, v60 quad_perm:[2,3,0,1] row_mask:0xf bank_mask:0xf
  s_nop 1
  v_add_f32_dpp v60, v60, v60 row_half_mirror row_mask:0xf bank_mask:0xf
  v_cvt_pk_bf16_f32 v60, v60, v60
  v_and_b32 v60, 0xffff0000, v60
  v_lshlrev_b32 v61, 16, v63
  v_add_f32 v60, v60, v61
  v_cvt_pk_bf16_f32 v60, v60, v60
  v_and_b32 v60, 0xffff0000, v60
  v_max_f32 v60, 0, v60
  v_mul_f32 v60, v60, v60
  v_cvt_pk_bf16_f32 v63, v60, v60
  v_lshrrev_b32 v58, 4, v1
  v_lshlrev_b32 v58, 5, v58
  v_add_u32 v59, 128, v58
  ds_bpermute_b32 v60, v58, v63
  ds_bpermute_b32 v61, v59, v63
  s_waitcnt lgkmcnt(0)
  s_lshr_b32 s46, s42, 1
  s_lshl_b32 s46, s46, 4
  s_and_b32 s47, s42, 1
  s_add_u32 s48, s46, s47
  s_add_u32 s48, s48, s43
  s_and_b32 s48, s48, 511
  s_mul_i32 s48, s48, 3072
  s_add_u32 s42, s42, 1
  s_and_b32 s42, s42, 63
  s_waitcnt vmcnt(1)
  buffer_load_dwordx4 v[100:103], v2, s[4:7], s48 offen offset:0 nt
  buffer_load_dwordx4 v[104:107], v2, s[4:7], s48 offen offset:128 nt
  buffer_load_dwordx4 v[108:111], v2, s[4:7], s48 offen offset:256 nt
  v_dot2_f32_bf16 v58, v88, v46, 0
  v_dot2_f32_bf16 v59, v92, v50, 0
  v_dot2_f32_bf16 v58, v96, v54, v58
  v_dot2_f32_bf16 v59, v89, v47, v59
  v_dot2_f32_bf16 v58, v93, v51, v58
  v_dot2_f32_bf16 v59, v97, v55, v59
  v_dot2_f32_bf16 v58, v90, v48, v58
  v_dot2_f32_bf16 v59, v94, v52, v59
  v_dot2_f32_bf16 v58, v98, v56, v58
  v_dot2_f32_bf16 v59, v91, v49, v59
  v_dot2_f32_bf16 v58, v95, v53, v58
  v_dot2_f32_bf16 v59, v99, v57, v59
  s_nop 2
  v_add_f32 v58, v58, v59
  s_nop 1
  v_add_f32_dpp v58, v58, v58 quad_perm:[1,0,3,2] row_mask:0xf bank_mask:0xf
  s_nop 1
  v_add_f32_dpp v58, v58, v58 quad_perm:[2,3,0,1] row_mask:0xf bank_mask:0xf
  s_nop 1
  v_add_f32_dpp v58, v58, v58 row_half_mirror row_mask:0xf bank_mask:0xf
  v_cndmask_b32 v42, v42, v58, s[56:57]
  s_mul_i32 s44, s3, 10240
  buffer_load_dwordx4 v[160:163], v5, s[24:27], s44 offen offset:512
  s_lshr_b32 s46, s42, 1
  s_lshl_b32 s46, s46, 4
  s_and_b32 s47, s42, 1
  s_add_u32 s48, s46, s47
  s_add_u32 s48, s48, s43
  s_and_b32 s48, s48, 511
  s_mul_i32 s48, s48, 3072
  s_add_u32 s42, s42, 1
  s_and_b32 s42, s42, 63
  s_waitcnt vmcnt(1)
  buffer_load_dwordx4 v[64:67], v2, s[4:7], s48 offen offset:0 nt
  buffer_load_dwordx4 v[68:71], v2, s[4:7], s48 offen offset:128 nt
  buffer_load_dwordx4 v[72:75], v2, s[4:7], s48 offen offset:256 nt
  v_dot2_f32_bf16 v58, v100, v46, 0
  v_dot2_f32_bf16 v59, v104, v50, 0
  v_dot2_f32_bf16 v58, v108, v54, v58
  v_dot2_f32_bf16 v59, v101, v47, v59
  v_dot2_f32_bf16 v58, v105, v51, v58
  v_dot2_f32_bf16 v59, v109, v55, v59
  v_dot2_f32_bf16 v58, v102, v48, v58
  v_dot2_f32_bf16 v59, v106, v52, v59
  v_dot2_f32_bf16 v58, v110, v56, v58
  v_dot2_f32_bf16 v59, v103, v49, v59
  v_dot2_f32_bf16 v58, v107, v53, v58
  v_dot2_f32_bf16 v59, v111, v57, v59
  s_nop 2
  v_add_f32 v58, v58, v59
  s_nop 1
  v_add_f32_dpp v58, v58, v58 quad_perm:[1,0,3,2] row_mask:0xf bank_mask:0xf
  s_nop 1
  v_add_f32_dpp v58, v58, v58 quad_perm:[2,3,0,1] row_mask:0xf bank_mask:0xf
  s_nop 1
  v_add_f32_dpp v58, v58, v58 row_half_mirror row_mask:0xf bank_mask:0xf
  v_cndmask_b32 v42, v42, v58, s[58:59]
  s_mul_i32 s44, s3, 10240
  buffer_load_dwordx4 v[164:167], v5, s[24:27], s44 offen offset:768
  s_lshr_b32 s46, s42, 1
  s_lshl_b32 s46, s46, 4
  s_and_b32 s47, s42, 1
  s_add_u32 s48, s46, s47
  s_add_u32 s48, s48, s43
  s_and_b32 s48, s48, 511
  s_mul_i32 s48, s48, 3072
  s_add_u32 s42, s42, 1
  s_and_b32 s42, s42, 63
  s_waitcnt vmcnt(1)
  buffer_load_dwordx4 v[76:79], v2, s[4:7], s48 offen offset:0 nt
  buffer_load_dwordx4 v[80:83], v2, s[4:7], s48 offen offset:128 nt
  buffer_load_dwordx4 v[84:87], v2, s[4:7], s48 offen offset:256 nt
  v_dot2_f32_bf16 v58, v64, v46, 0
  v_dot2_f32_bf16 v59, v68, v50, 0
  v_dot2_f32_bf16 v58, v72, v54, v58
  v_dot2_f32_bf16 v59, v65, v47, v59
  v_dot2_f32_bf16 v58, v69, v51, v58
  v_dot2_f32_bf16 v59, v73, v55, v59
  v_dot2_f32_bf16 v58, v66, v48, v58
  v_dot2_f32_bf16 v59, v70, v52, v59
  v_dot2_f32_bf16 v58, v74, v56, v58
  v_dot2_f32_bf16 v59, v67, v49, v59
  v_dot2_f32_bf16 v58, v71, v53, v58
  v_dot2_f32_bf16 v59, v75, v57, v59
  s_nop 2
  v_add_f32 v58, v58, v59
  s_nop 1
  v_add_f32_dpp v58, v58, v58 quad_perm:[1,0,3,2] row_mask:0xf bank_mask:0xf
  s_nop 1
  v_add_f32_dpp v58, v58, v58 quad_perm:[2,3,0,1] row_mask:0xf bank_mask:0xf
  s_nop 1
  v_add_f32_dpp v58, v58, v58 row_half_mirror row_mask:0xf bank_mask:0xf
  v_cndmask_b32 v42, v42, v58, s[60:61]
  s_mul_i32 s44, s3, 10240
  buffer_load_dwordx4 v[168:171], v5, s[24:27], s44 offen offset:1024
  s_lshr_b32 s46, s42, 1
  s_lshl_b32 s46, s46, 4
  s_and_b32 s47, s42, 1
  s_add_u32 s48, s46, s47
  s_add_u32 s48, s48, s43
  s_and_b32 s48, s48, 511
  s_mul_i32 s48, s48, 3072
  s_add_u32 s42, s42, 1
  s_and_b32 s42, s42, 63
  s_waitcnt vmcnt(1)
  buffer_load_dwordx4 v[88:91], v2, s[4:7], s48 offen offset:0 nt
  buffer_load_dwordx4 v[92:95], v2, s[4:7], s48 offen offset:128 nt
  buffer_load_dwordx4 v[96:99], v2, s[4:7], s48 offen offset:256 nt
  v_dot2_f32_bf16 v58, v76, v46, 0
  v_dot2_f32_bf16 v59, v80, v50, 0
  v_dot2_f32_bf16 v58, v84, v54, v58
  v_dot2_f32_bf16 v59, v77, v47, v59
  v_dot2_f32_bf16 v58, v81, v51, v58
  v_dot2_f32_bf16 v59, v85, v55, v59
  v_dot2_f32_bf16 v58, v78, v48, v58
  v_dot2_f32_bf16 v59, v82, v52, v59
  v_dot2_f32_bf16 v58, v86, v56, v58
  v_dot2_f32_bf16 v59, v79, v49, v59
  v_dot2_f32_bf16 v58, v83, v53, v58
  v_dot2_f32_bf16 v59, v87, v57, v59
  s_nop 2
  v_add_f32 v58, v58, v59
  s_nop 1
  v_add_f32_dpp v58, v58, v58 quad_perm:[1,0,3,2] row_mask:0xf bank_mask:0xf
  s_nop 1
  v_add_f32_dpp v58, v58, v58 quad_perm:[2,3,0,1] row_mask:0xf bank_mask:0xf
  s_nop 1
  v_add_f32_dpp v58, v58, v58 row_half_mirror row_mask:0xf bank_mask:0xf
  v_cndmask_b32 v42, v42, v58, s[62:63]
  s_mul_i32 s44, s3, 10240
  s_add_u32 s44, s44, 5120
  buffer_load_dwordx4 v[172:175], v5, s[24:27], s44 offen offset:0
  s_lshr_b32 s46, s42, 1
  s_lshl_b32 s46, s46, 4
  s_and_b32 s47, s42, 1
  s_add_u32 s48, s46, s47
  s_add_u32 s48, s48, s43
  s_and_b32 s48, s48, 511
  s_mul_i32 s48, s48, 3072
  s_add_u32 s42, s42, 1
  s_and_b32 s42, s42, 63
  s_waitcnt vmcnt(1)
  buffer_load_dwordx4 v[100:103], v2, s[4:7], s48 offen offset:0 nt
  buffer_load_dwordx4 v[104:107], v2, s[4:7], s48 offen offset:128 nt
  buffer_load_dwordx4 v[108:111], v2, s[4:7], s48 offen offset:256 nt
  v_dot2_f32_bf16 v58, v88, v46, 0
  v_dot2_f32_bf16 v59, v92, v50, 0
  v_dot2_f32_bf16 v58, v96, v54, v58
  v_dot2_f32_bf16 v59, v89, v47, v59
  v_dot2_f32_bf16 v58, v93, v51, v58
  v_dot2_f32_bf16 v59, v97, v55, v59
  v_dot2_f32_bf16 v58, v90, v48, v58
  v_dot2_f32_bf16 v59, v94, v52, v59
  v_dot2_f32_bf16 v58, v98, v56, v58
  v_dot2_f32_bf16 v59, v91, v49, v59
  v_dot2_f32_bf16 v58, v95, v53, v58
  v_dot2_f32_bf16 v59, v99, v57, v59
  s_nop 2
  v_add_f32 v58, v58, v59
  s_nop 1
  v_add_f32_dpp v58, v58, v58 quad_perm:[1,0,3,2] row_mask:0xf bank_mask:0xf
  s_nop 1
  v_add_f32_dpp v58, v58, v58 quad_perm:[2,3,0,1] row_mask:0xf bank_mask:0xf
  s_nop 1
  v_add_f32_dpp v58, v58, v58 row_half_mirror row_mask:0xf bank_mask:0xf
  v_cndmask_b32 v42, v42, v58, s[64:65]
  s_mul_i32 s44, s3, 10240
  s_add_u32 s44, s44, 5120
  buffer_load_dwordx4 v[176:179], v5, s[24:27], s44 offen offset:256
  s_lshr_b32 s46, s42, 1
  s_lshl_b32 s46, s46, 4
  s_and_b32 s47, s42, 1
  s_add_u32 s48, s46, s47
  s_add_u32 s48, s48, s43
  s_and_b32 s48, s48, 511
  s_mul_i32 s48, s48, 3072
  s_add_u32 s42, s42, 1
  s_and_b32 s42, s42, 63
  s_waitcnt vmcnt(1)
  buffer_load_dwordx4 v[64:67], v2, s[4:7], s48 offen offset:0 nt
  buffer_load_dwordx4 v[68:71], v2, s[4:7], s48 offen offset:128 nt
  buffer_load_dwordx4 v[72:75], v2, s[4:7], s48 offen offset:256 nt
  v_dot2_f32_bf16 v58, v100, v46, 0
  v_dot2_f32_bf16 v59, v104, v50, 0
  v_dot2_f32_bf16 v58, v108, v54, v58
  v_dot2_f32_bf16 v59, v101, v47, v59
  v_dot2_f32_bf16 v58, v105, v51, v58
  v_dot2_f32_bf16 v59, v109, v55, v59
  v_dot2_f32_bf16 v58, v102, v48, v58
  v_dot2_f32_bf16 v59, v106, v52, v59
  v_dot2_f32_bf16 v58, v110, v56, v58
  v_dot2_f32_bf16 v59, v103, v49, v59
  v_dot2_f32_bf16 v58, v107, v53, v58
  v_dot2_f32_bf16 v59, v111, v57, v59
  s_nop 2
  v_add_f32 v58, v58, v59
  s_nop 1
  v_add_f32_dpp v58, v58, v58 quad_perm:[1,0,3,2] row_mask:0xf bank_mask:0xf
  s_nop 1
  v_add_f32_dpp v58, v58, v58 quad_perm:[2,3,0,1] row_mask:0xf bank_mask:0xf
  s_nop 1
  v_add_f32_dpp v58, v58, v58 row_half_mirror row_mask:0xf bank_mask:0xf
  v_cndmask_b32 v42, v42, v58, s[66:67]
  s_mul_i32 s44, s3, 10240
  s_add_u32 s44, s44, 5120
  buffer_load_dwordx4 v[180:183], v5, s[24:27], s44 offen offset:512
  s_lshr_b32 s46, s42, 1
  s_lshl_b32 s46, s46, 4
  s_and_b32 s47, s42, 1
  s_add_u32 s48, s46, s47
  s_add_u32 s48, s48, s43
  s_and_b32 s48, s48, 511
  s_mul_i32 s48, s48, 3072
  s_add_u32 s42, s42, 1
  s_and_b32 s42, s42, 63
  s_waitcnt vmcnt(1)
  buffer_load_dwordx4 v[76:79], v2, s[4:7], s48 offen offset:0 nt
  buffer_load_dwordx4 v[80:83], v2, s[4:7], s48 offen offset:128 nt
  buffer_load_dwordx4 v[84:87], v2, s[4:7], s48 offen offset:256 nt
  v_dot2_f32_bf16 v58, v64, v46, 0
  v_dot2_f32_bf16 v59, v68, v50, 0
  v_dot2_f32_bf16 v58, v72, v54, v58
  v_dot2_f32_bf16 v59, v65, v47, v59
  v_dot2_f32_bf16 v58, v69, v51, v58
  v_dot2_f32_bf16 v59, v73, v55, v59
  v_dot2_f32_bf16 v58, v66, v48, v58
  v_dot2_f32_bf16 v59, v70, v52, v59
  v_dot2_f32_bf16 v58, v74, v56, v58
  v_dot2_f32_bf16 v59, v67, v49, v59
  v_dot2_f32_bf16 v58, v71, v53, v58
  v_dot2_f32_bf16 v59, v75, v57, v59
  s_nop 2
  v_add_f32 v58, v58, v59
  s_nop 1
  v_add_f32_dpp v58, v58, v58 quad_perm:[1,0,3,2] row_mask:0xf bank_mask:0xf
  s_nop 1
  v_add_f32_dpp v58, v58, v58 quad_perm:[2,3,0,1] row_mask:0xf bank_mask:0xf
  s_nop 1
  v_add_f32_dpp v58, v58, v58 row_half_mirror row_mask:0xf bank_mask:0xf
  v_mov_b32 v43, v58
  s_mul_i32 s44, s3, 10240
  s_add_u32 s44, s44, 5120
  buffer_load_dwordx4 v[184:187], v5, s[24:27], s44 offen offset:768
  s_lshr_b32 s46, s42, 1
  s_lshl_b32 s46, s46, 4
  s_and_b32 s47, s42, 1
  s_add_u32 s48, s46, s47
  s_add_u32 s48, s48, s43
  s_and_b32 s48, s48, 511
  s_mul_i32 s48, s48, 3072
  s_add_u32 s42, s42, 1
  s_and_b32 s42, s42, 63
  s_waitcnt vmcnt(1)
  buffer_load_dwordx4 v[88:91], v2, s[4:7], s48 offen offset:0 nt
  buffer_load_dwordx4 v[92:95], v2, s[4:7], s48 offen offset:128 nt
  buffer_load_dwordx4 v[96:99], v2, s[4:7], s48 offen offset:256 nt
  v_dot2_f32_bf16 v58, v76, v46, 0
  v_dot2_f32_bf16 v59, v80, v50, 0
  v_dot2_f32_bf16 v58, v84, v54, v58
  v_dot2_f32_bf16 v59, v77, v47, v59
  v_dot2_f32_bf16 v58, v81, v51, v58
  v_dot2_f32_bf16 v59, v85, v55, v59
  v_dot2_f32_bf16 v58, v78, v48, v58
  v_dot2_f32_bf16 v59, v82, v52, v59
  v_dot2_f32_bf16 v58, v86, v56, v58
  v_dot2_f32_bf16 v59, v79, v49, v59
  v_dot2_f32_bf16 v58, v83, v53, v58
  v_dot2_f32_bf16 v59, v87, v57, v59
  s_nop 2
  v_add_f32 v58, v58, v59
  s_nop 1
  v_add_f32_dpp v58, v58, v58 quad_perm:[1,0,3,2] row_mask:0xf bank_mask:0xf
  s_nop 1
  v_add_f32_dpp v58, v58, v58 quad_perm:[2,3,0,1] row_mask:0xf bank_mask:0xf
  s_nop 1
  v_add_f32_dpp v58, v58, v58 row_half_mirror row_mask:0xf bank_mask:0xf
  v_cndmask_b32 v43, v43, v58, s[54:55]
  s_mul_i32 s44, s3, 10240
  s_add_u32 s44, s44, 5120
  buffer_load_dwordx4 v[188:191], v5, s[24:27], s44 offen offset:1024
  s_lshr_b32 s46, s42, 1
  s_lshl_b32 s46, s46, 4
  s_and_b32 s47, s42, 1
  s_add_u32 s48, s46, s47
  s_add_u32 s48, s48, s43
  s_and_b32 s48, s48, 511
  s_mul_i32 s48, s48, 3072
  s_add_u32 s42, s42, 1
  s_and_b32 s42, s42, 63
  s_waitcnt vmcnt(1)
  buffer_load_dwordx4 v[100:103], v2, s[4:7], s48 offen offset:0 nt
  buffer_load_dwordx4 v[104:107], v2, s[4:7], s48 offen offset:128 nt
  buffer_load_dwordx4 v[108:111], v2, s[4:7], s48 offen offset:256 nt
  v_dot2_f32_bf16 v58, v88, v46, 0
  v_dot2_f32_bf16 v59, v92, v50, 0
  v_dot2_f32_bf16 v58, v96, v54, v58
  v_dot2_f32_bf16 v59, v89, v47, v59
  v_dot2_f32_bf16 v58, v93, v51, v58
  v_dot2_f32_bf16 v59, v97, v55, v59
  v_dot2_f32_bf16 v58, v90, v48, v58
  v_dot2_f32_bf16 v59, v94, v52, v59
  v_dot2_f32_bf16 v58, v98, v56, v58
  v_dot2_f32_bf16 v59, v91, v49, v59
  v_dot2_f32_bf16 v58, v95, v53, v58
  v_dot2_f32_bf16 v59, v99, v57, v59
  s_nop 2
  v_add_f32 v58, v58, v59
  s_nop 1
  v_add_f32_dpp v58, v58, v58 quad_perm:[1,0,3,2] row_mask:0xf bank_mask:0xf
  s_nop 1
  v_add_f32_dpp v58, v58, v58 quad_perm:[2,3,0,1] row_mask:0xf bank_mask:0xf
  s_nop 1
  v_add_f32_dpp v58, v58, v58 row_half_mirror row_mask:0xf bank_mask:0xf
  v_cndmask_b32 v43, v43, v58, s[56:57]
  s_lshr_b32 s46, s42, 1
  s_lshl_b32 s46, s46, 4
  s_and_b32 s47, s42, 1
  s_add_u32 s48, s46, s47
  s_add_u32 s48, s48, s43
  s_and_b32 s48, s48, 511
  s_mul_i32 s48, s48, 3072
  s_add_u32 s42, s42, 1
  s_and_b32 s42, s42, 63
  s_waitcnt vmcnt(0)
  buffer_load_dwordx4 v[64:67], v2, s[4:7], s48 offen offset:0 nt
  buffer_load_dwordx4 v[68:71], v2, s[4:7], s48 offen offset:128 nt
  buffer_load_dwordx4 v[72:75], v2, s[4:7], s48 offen offset:256 nt
  v_dot2_f32_bf16 v58, v100, v46, 0
  v_dot2_f32_bf16 v59, v104, v50, 0
  v_dot2_f32_bf16 v58, v108, v54, v58
  v_dot2_f32_bf16 v59, v101, v47, v59
  v_dot2_f32_bf16 v58, v105, v51, v58
  v_dot2_f32_bf16 v59, v109, v55, v59
  v_dot2_f32_bf16 v58, v102, v48, v58
  v_dot2_f32_bf16 v59, v106, v52, v59
  v_dot2_f32_bf16 v58, v110, v56, v58
  v_dot2_f32_bf16 v59, v103, v49, v59
  v_dot2_f32_bf16 v58, v107, v53, v58
  v_dot2_f32_bf16 v59, v111, v57, v59
  s_nop 2
  v_add_f32 v58, v58, v59
  s_nop 1
  v_add_f32_dpp v58, v58, v58 quad_perm:[1,0,3,2] row_mask:0xf bank_mask:0xf
  s_nop 1
  v_add_f32_dpp v58, v58, v58 quad_perm:[2,3,0,1] row_mask:0xf bank_mask:0xf
  s_nop 1
  v_add_f32_dpp v58, v58, v58 row_half_mirror row_mask:0xf bank_mask:0xf
  v_cndmask_b32 v43, v43, v58, s[58:59]
  v_and_b32 v14, v60, v10
  v_and_b32 v15, v60, v11
  v_and_b32 v16, v60, v12
  v_and_b32 v17, v60, v13
  v_and_b32 v18, v61, v10
  v_and_b32 v19, v61, v11
  v_and_b32 v20, v61, v12
  v_and_b32 v21, v61, v13
  s_nop 0
  v_mfma_f32_16x16x32_bf16 v[192:195], v[14:17], v[152:155], 0
  v_mfma_f32_16x16x32_bf16 v[196:199], v[14:17], v[156:159], 0
  v_mfma_f32_16x16x32_bf16 v[200:203], v[14:17], v[160:163], 0
  v_mfma_f32_16x16x32_bf16 v[204:207], v[14:17], v[164:167], 0
  v_mfma_f32_16x16x32_bf16 v[208:211], v[14:17], v[168:171], 0
  v_mfma_f32_16x16x32_bf16 v[192:195], v[18:21], v[172:175], v[192:195]
  v_mfma_f32_16x16x32_bf16 v[196:199], v[18:21], v[176:179], v[196:199]
  v_mfma_f32_16x16x32_bf16 v[200:203], v[18:21], v[180:183], v[200:203]
  v_mfma_f32_16x16x32_bf16 v[204:207], v[18:21], v[184:187], v[204:207]
  v_mfma_f32_16x16x32_bf16 v[208:211], v[18:21], v[188:191], v[208:211]
  s_lshr_b32 s46, s42, 1
  s_lshl_b32 s46, s46, 4
  s_and_b32 s47, s42, 1
  s_add_u32 s48, s46, s47
  s_add_u32 s48, s48, s43
  s_and_b32 s48, s48, 511
  s_mul_i32 s48, s48, 3072
  s_add_u32 s42, s42, 1
  s_and_b32 s42, s42, 63
  s_waitcnt vmcnt(0)
  buffer_load_dwordx4 v[76:79], v2, s[4:7], s48 offen offset:0 nt
  buffer_load_dwordx4 v[80:83], v2, s[4:7], s48 offen offset:128 nt
  buffer_load_dwordx4 v[84:87], v2, s[4:7], s48 offen offset:256 nt
  v_dot2_f32_bf16 v58, v64, v46, 0
  v_dot2_f32_bf16 v59, v68, v50, 0
  v_dot2_f32_bf16 v58, v72, v54, v58
  v_dot2_f32_bf16 v59, v65, v47, v59
  v_dot2_f32_bf16 v58, v69, v51, v58
  v_dot2_f32_bf16 v59, v73, v55, v59
  v_dot2_f32_bf16 v58, v66, v48, v58
  v_dot2_f32_bf16 v59, v70, v52, v59
  v_dot2_f32_bf16 v58, v74, v56, v58
  v_dot2_f32_bf16 v59, v67, v49, v59
  v_dot2_f32_bf16 v58, v71, v53, v58
  v_dot2_f32_bf16 v59, v75, v57, v59
  s_nop 2
  v_add_f32 v58, v58, v59
  s_nop 1
  v_add_f32_dpp v58, v58, v58 quad_perm:[1,0,3,2] row_mask:0xf bank_mask:0xf
  s_nop 1
  v_add_f32_dpp v58, v58, v58 quad_perm:[2,3,0,1] row_mask:0xf bank_mask:0xf
  s_nop 1
  v_add_f32_dpp v58, v58, v58 row_half_mirror row_mask:0xf bank_mask:0xf
  v_cndmask_b32 v43, v43, v58, s[60:61]
  s_mov_b32 exec_hi, 0
  ds_write_b128 v62, v[192:195] offset:36096
  ds_write_b128 v62, v[196:199] offset:36608
  ds_write_b128 v62, v[200:203] offset:37120
  ds_write_b128 v62, v[204:207] offset:37632
  ds_write_b128 v62, v[208:211] offset:38144
  s_mov_b64 exec, -1
  s_lshr_b32 s46, s42, 1
  s_lshl_b32 s46, s46, 4
  s_and_b32 s47, s42, 1
  s_add_u32 s48, s46, s47
  s_add_u32 s48, s48, s43
  s_and_b32 s48, s48, 511
  s_mul_i32 s48, s48, 3072
  s_add_u32 s42, s42, 1
  s_and_b32 s42, s42, 63
  s_waitcnt vmcnt(0)
  buffer_load_dwordx4 v[88:91], v2, s[4:7], s48 offen offset:0 nt
  buffer_load_dwordx4 v[92:95], v2, s[4:7], s48 offen offset:128 nt
  buffer_load_dwordx4 v[96:99], v2, s[4:7], s48 offen offset:256 nt
  v_dot2_f32_bf16 v58, v76, v46, 0
  v_dot2_f32_bf16 v59, v80, v50, 0
  v_dot2_f32_bf16 v58, v84, v54, v58
  v_dot2_f32_bf16 v59, v77, v47, v59
  v_dot2_f32_bf16 v58, v81, v51, v58
  v_dot2_f32_bf16 v59, v85, v55, v59
  v_dot2_f32_bf16 v58, v78, v48, v58
  v_dot2_f32_bf16 v59, v82, v52, v59
  v_dot2_f32_bf16 v58, v86, v56, v58
  v_dot2_f32_bf16 v59, v79, v49, v59
  v_dot2_f32_bf16 v58, v83, v53, v58
  v_dot2_f32_bf16 v59, v87, v57, v59
  s_nop 2
  v_add_f32 v58, v58, v59
  s_nop 1
  v_add_f32_dpp v58, v58, v58 quad_perm:[1,0,3,2] row_mask:0xf bank_mask:0xf
  s_nop 1
  v_add_f32_dpp v58, v58, v58 quad_perm:[2,3,0,1] row_mask:0xf bank_mask:0xf
  s_nop 1
  v_add_f32_dpp v58, v58, v58 row_half_mirror row_mask:0xf bank_mask:0xf
  v_cndmask_b32 v43, v43, v58, s[62:63]
  s_lshr_b32 s46, s42, 1
  s_lshl_b32 s46, s46, 4
  s_and_b32 s47, s42, 1
  s_add_u32 s48, s46, s47
  s_add_u32 s48, s48, s43
  s_and_b32 s48, s48, 511
  s_mul_i32 s48, s48, 3072
  s_add_u32 s42, s42, 1
  s_and_b32 s42, s42, 63
  s_waitcnt vmcnt(0)
  buffer_load_dwordx4 v[100:103], v2, s[4:7], s48 offen offset:0 nt
  buffer_load_dwordx4 v[104:107], v2, s[4:7], s48 offen offset:128 nt
  buffer_load_dwordx4 v[108:111], v2, s[4:7], s48 offen offset:256 nt
  v_dot2_f32_bf16 v58, v88, v46, 0
  v_dot2_f32_bf16 v59, v92, v50, 0
  v_dot2_f32_bf16 v58, v96, v54, v58
  v_dot2_f32_bf16 v59, v89, v47, v59
  v_dot2_f32_bf16 v58, v93, v51, v58
  v_dot2_f32_bf16 v59, v97, v55, v59
  v_dot2_f32_bf16 v58, v90, v48, v58
  v_dot2_f32_bf16 v59, v94, v52, v59
  v_dot2_f32_bf16 v58, v98, v56, v58
  v_dot2_f32_bf16 v59, v91, v49, v59
  v_dot2_f32_bf16 v58, v95, v53, v58
  v_dot2_f32_bf16 v59, v99, v57, v59
  s_nop 2
  v_add_f32 v58, v58, v59
  s_nop 1
  v_add_f32_dpp v58, v58, v58 quad_perm:[1,0,3,2] row_mask:0xf bank_mask:0xf
  s_nop 1
  v_add_f32_dpp v58, v58, v58 quad_perm:[2,3,0,1] row_mask:0xf bank_mask:0xf
  s_nop 1
  v_add_f32_dpp v58, v58, v58 row_half_mirror row_mask:0xf bank_mask:0xf
  v_cndmask_b32 v43, v43, v58, s[64:65]
  s_mul_i32 s49, s3, 30720
  buffer_load_dwordx4 v[112:115], v5, s[16:19], s49 offen offset:0
  s_lshr_b32 s46, s42, 1
  s_lshl_b32 s46, s46, 4
  s_and_b32 s47, s42, 1
  s_add_u32 s48, s46, s47
  s_add_u32 s48, s48, s43
  s_and_b32 s48, s48, 511
  s_mul_i32 s48, s48, 3072
  s_add_u32 s42, s42, 1
  s_and_b32 s42, s42, 63
  s_waitcnt vmcnt(1)
  buffer_load_dwordx4 v[64:67], v2, s[4:7], s48 offen offset:0 nt
  buffer_load_dwordx4 v[68:71], v2, s[4:7], s48 offen offset:128 nt
  buffer_load_dwordx4 v[72:75], v2, s[4:7], s48 offen offset:256 nt
  v_dot2_f32_bf16 v58, v100, v46, 0
  v_dot2_f32_bf16 v59, v104, v50, 0
  v_dot2_f32_bf16 v58, v108, v54, v58
  v_dot2_f32_bf16 v59, v101, v47, v59
  v_dot2_f32_bf16 v58, v105, v51, v58
  v_dot2_f32_bf16 v59, v109, v55, v59
  v_dot2_f32_bf16 v58, v102, v48, v58
  v_dot2_f32_bf16 v59, v106, v52, v59
  v_dot2_f32_bf16 v58, v110, v56, v58
  v_dot2_f32_bf16 v59, v103, v49, v59
  v_dot2_f32_bf16 v58, v107, v53, v58
  v_dot2_f32_bf16 v59, v111, v57, v59
  s_nop 2
  v_add_f32 v58, v58, v59
  s_nop 1
  v_add_f32_dpp v58, v58, v58 quad_perm:[1,0,3,2] row_mask:0xf bank_mask:0xf
  s_nop 1
  v_add_f32_dpp v58, v58, v58 quad_perm:[2,3,0,1] row_mask:0xf bank_mask:0xf
  s_nop 1
  v_add_f32_dpp v58, v58, v58 row_half_mirror row_mask:0xf bank_mask:0xf
  v_cndmask_b32 v43, v43, v58, s[66:67]
  s_lshr_b32 s46, s42, 1
  s_lshl_b32 s46, s46, 4
  s_and_b32 s47, s42, 1
  s_add_u32 s48, s46, s47
  s_add_u32 s48, s48, s43
  s_and_b32 s48, s48, 511
  s_mul_i32 s48, s48, 3072
  s_add_u32 s42, s42, 1
  s_and_b32 s42, s42, 63
  s_waitcnt vmcnt(0)
  buffer_load_dwordx4 v[76:79], v2, s[4:7], s48 offen offset:0 nt
  buffer_load_dwordx4 v[80:83], v2, s[4:7], s48 offen offset:128 nt
  buffer_load_dwordx4 v[84:87], v2, s[4:7], s48 offen offset:256 nt
  v_dot2_f32_bf16 v58, v64, v46, 0
  v_dot2_f32_bf16 v59, v68, v50, 0
  v_dot2_f32_bf16 v58, v72, v54, v58
  v_dot2_f32_bf16 v59, v65, v47, v59
  v_dot2_f32_bf16 v58, v69, v51, v58
  v_dot2_f32_bf16 v59, v73, v55, v59
  v_dot2_f32_bf16 v58, v66, v48, v58
  v_dot2_f32_bf16 v59, v70, v52, v59
  v_dot2_f32_bf16 v58, v74, v56, v58
  v_dot2_f32_bf16 v59, v67, v49, v59
  v_dot2_f32_bf16 v58, v71, v53, v58
  v_dot2_f32_bf16 v59, v75, v57, v59
  s_nop 2
  v_add_f32 v58, v58, v59
  s_nop 1
  v_add_f32_dpp v58, v58, v58 quad_perm:[1,0,3,2] row_mask:0xf bank_mask:0xf
  s_nop 1
  v_add_f32_dpp v58, v58, v58 quad_perm:[2,3,0,1] row_mask:0xf bank_mask:0xf
  s_nop 1
  v_add_f32_dpp v58, v58, v58 row_half_mirror row_mask:0xf bank_mask:0xf
  v_mov_b32 v44, v58
  buffer_load_dwordx4 v[116:119], v5, s[16:19], s49 offen offset:256
  s_lshr_b32 s46, s42, 1
  s_lshl_b32 s46, s46, 4
  s_and_b32 s47, s42, 1
  s_add_u32 s48, s46, s47
  s_add_u32 s48, s48, s43
  s_and_b32 s48, s48, 511
  s_mul_i32 s48, s48, 3072
  s_add_u32 s42, s42, 1
  s_and_b32 s42, s42, 63
  s_waitcnt vmcnt(1)
  buffer_load_dwordx4 v[88:91], v2, s[4:7], s48 offen offset:0 nt
  buffer_load_dwordx4 v[92:95], v2, s[4:7], s48 offen offset:128 nt
  buffer_load_dwordx4 v[96:99], v2, s[4:7], s48 offen offset:256 nt
  v_dot2_f32_bf16 v58, v76, v46, 0
  v_dot2_f32_bf16 v59, v80, v50, 0
  v_dot2_f32_bf16 v58, v84, v54, v58
  v_dot2_f32_bf16 v59, v77, v47, v59
  v_dot2_f32_bf16 v58, v81, v51, v58
  v_dot2_f32_bf16 v59, v85, v55, v59
  v_dot2_f32_bf16 v58, v78, v48, v58
  v_dot2_f32_bf16 v59, v82, v52, v59
  v_dot2_f32_bf16 v58, v86, v56, v58
  v_dot2_f32_bf16 v59, v79, v49, v59
  v_dot2_f32_bf16 v58, v83, v53, v58
  v_dot2_f32_bf16 v59, v87, v57, v59
  s_nop 2
  v_add_f32 v58, v58, v59
  s_nop 1
  v_add_f32_dpp v58, v58, v58 quad_perm:[1,0,3,2] row_mask:0xf bank_mask:0xf
  s_nop 1
  v_add_f32_dpp v58, v58, v58 quad_perm:[2,3,0,1] row_mask:0xf bank_mask:0xf
  s_nop 1
  v_add_f32_dpp v58, v58, v58 row_half_mirror row_mask:0xf bank_mask:0xf
  v_cndmask_b32 v44, v44, v58, s[54:55]
  s_lshr_b32 s46, s42, 1
  s_lshl_b32 s46, s46, 4
  s_and_b32 s47, s42, 1
  s_add_u32 s48, s46, s47
  s_add_u32 s48, s48, s43
  s_and_b32 s48, s48, 511
  s_mul_i32 s48, s48, 3072
  s_add_u32 s42, s42, 1
  s_and_b32 s42, s42, 63
  s_waitcnt vmcnt(0)
  buffer_load_dwordx4 v[100:103], v2, s[4:7], s48 offen offset:0 nt
  buffer_load_dwordx4 v[104:107], v2, s[4:7], s48 offen offset:128 nt
  buffer_load_dwordx4 v[108:111], v2, s[4:7], s48 offen offset:256 nt
  v_dot2_f32_bf16 v58, v88, v46, 0
  v_dot2_f32_bf16 v59, v92, v50, 0
  v_dot2_f32_bf16 v58, v96, v54, v58
  v_dot2_f32_bf16 v59, v89, v47, v59
  v_dot2_f32_bf16 v58, v93, v51, v58
  v_dot2_f32_bf16 v59, v97, v55, v59
  v_dot2_f32_bf16 v58, v90, v48, v58
  v_dot2_f32_bf16 v59, v94, v52, v59
  v_dot2_f32_bf16 v58, v98, v56, v58
  v_dot2_f32_bf16 v59, v91, v49, v59
  v_dot2_f32_bf16 v58, v95, v53, v58
  v_dot2_f32_bf16 v59, v99, v57, v59
  s_nop 2
  v_add_f32 v58, v58, v59
  s_nop 1
  v_add_f32_dpp v58, v58, v58 quad_perm:[1,0,3,2] row_mask:0xf bank_mask:0xf
  s_nop 1
  v_add_f32_dpp v58, v58, v58 quad_perm:[2,3,0,1] row_mask:0xf bank_mask:0xf
  s_nop 1
  v_add_f32_dpp v58, v58, v58 row_half_mirror row_mask:0xf bank_mask:0xf
  v_cndmask_b32 v44, v44, v58, s[56:57]
  buffer_load_dwordx4 v[120:123], v5, s[16:19], s49 offen offset:512
  s_lshr_b32 s46, s42, 1
  s_lshl_b32 s46, s46, 4
  s_and_b32 s47, s42, 1
  s_add_u32 s48, s46, s47
  s_add_u32 s48, s48, s43
  s_and_b32 s48, s48, 511
  s_mul_i32 s48, s48, 3072
  s_add_u32 s42, s42, 1
  s_and_b32 s42, s42, 63
  s_waitcnt vmcnt(1)
  buffer_load_dwordx4 v[64:67], v2, s[4:7], s48 offen offset:0 nt
  buffer_load_dwordx4 v[68:71], v2, s[4:7], s48 offen offset:128 nt
  buffer_load_dwordx4 v[72:75], v2, s[4:7], s48 offen offset:256 nt
  v_dot2_f32_bf16 v58, v100, v46, 0
  v_dot2_f32_bf16 v59, v104, v50, 0
  v_dot2_f32_bf16 v58, v108, v54, v58
  v_dot2_f32_bf16 v59, v101, v47, v59
  v_dot2_f32_bf16 v58, v105, v51, v58
  v_dot2_f32_bf16 v59, v109, v55, v59
  v_dot2_f32_bf16 v58, v102, v48, v58
  v_dot2_f32_bf16 v59, v106, v52, v59
  v_dot2_f32_bf16 v58, v110, v56, v58
  v_dot2_f32_bf16 v59, v103, v49, v59
  v_dot2_f32_bf16 v58, v107, v53, v58
  v_dot2_f32_bf16 v59, v111, v57, v59
  s_nop 2
  v_add_f32 v58, v58, v59
  s_nop 1
  v_add_f32_dpp v58, v58, v58 quad_perm:[1,0,3,2] row_mask:0xf bank_mask:0xf
  s_nop 1
  v_add_f32_dpp v58, v58, v58 quad_perm:[2,3,0,1] row_mask:0xf bank_mask:0xf
  s_nop 1
  v_add_f32_dpp v58, v58, v58 row_half_mirror row_mask:0xf bank_mask:0xf
  v_cndmask_b32 v44, v44, v58, s[58:59]
  s_lshr_b32 s46, s42, 1
  s_lshl_b32 s46, s46, 4
  s_and_b32 s47, s42, 1
  s_add_u32 s48, s46, s47
  s_add_u32 s48, s48, s43
  s_and_b32 s48, s48, 511
  s_mul_i32 s48, s48, 3072
  s_add_u32 s42, s42, 1
  s_and_b32 s42, s42, 63
  s_waitcnt vmcnt(0)
  buffer_load_dwordx4 v[76:79], v2, s[4:7], s48 offen offset:0 nt
  buffer_load_dwordx4 v[80:83], v2, s[4:7], s48 offen offset:128 nt
  buffer_load_dwordx4 v[84:87], v2, s[4:7], s48 offen offset:256 nt
  v_dot2_f32_bf16 v58, v64, v46, 0
  v_dot2_f32_bf16 v59, v68, v50, 0
  v_dot2_f32_bf16 v58, v72, v54, v58
  v_dot2_f32_bf16 v59, v65, v47, v59
  v_dot2_f32_bf16 v58, v69, v51, v58
  v_dot2_f32_bf16 v59, v73, v55, v59
  v_dot2_f32_bf16 v58, v66, v48, v58
  v_dot2_f32_bf16 v59, v70, v52, v59
  v_dot2_f32_bf16 v58, v74, v56, v58
  v_dot2_f32_bf16 v59, v67, v49, v59
  v_dot2_f32_bf16 v58, v71, v53, v58
  v_dot2_f32_bf16 v59, v75, v57, v59
  s_nop 2
  v_add_f32 v58, v58, v59
  s_nop 1
  v_add_f32_dpp v58, v58, v58 quad_perm:[1,0,3,2] row_mask:0xf bank_mask:0xf
  s_nop 1
  v_add_f32_dpp v58, v58, v58 quad_perm:[2,3,0,1] row_mask:0xf bank_mask:0xf
  s_nop 1
  v_add_f32_dpp v58, v58, v58 row_half_mirror row_mask:0xf bank_mask:0xf
  v_cndmask_b32 v44, v44, v58, s[60:61]
  buffer_load_dwordx4 v[124:127], v5, s[16:19], s49 offen offset:768
  s_lshr_b32 s46, s42, 1
  s_lshl_b32 s46, s46, 4
  s_and_b32 s47, s42, 1
  s_add_u32 s48, s46, s47
  s_add_u32 s48, s48, s43
  s_and_b32 s48, s48, 511
  s_mul_i32 s48, s48, 3072
  s_add_u32 s42, s42, 1
  s_and_b32 s42, s42, 63
  s_waitcnt vmcnt(1)
  buffer_load_dwordx4 v[88:91], v2, s[4:7], s48 offen offset:0 nt
  buffer_load_dwordx4 v[92:95], v2, s[4:7], s48 offen offset:128 nt
  buffer_load_dwordx4 v[96:99], v2, s[4:7], s48 offen offset:256 nt
  v_dot2_f32_bf16 v58, v76, v46, 0
  v_dot2_f32_bf16 v59, v80, v50, 0
  v_dot2_f32_bf16 v58, v84, v54, v58
  v_dot2_f32_bf16 v59, v77, v47, v59
  v_dot2_f32_bf16 v58, v81, v51, v58
  v_dot2_f32_bf16 v59, v85, v55, v59
  v_dot2_f32_bf16 v58, v78, v48, v58
  v_dot2_f32_bf16 v59, v82, v52, v59
  v_dot2_f32_bf16 v58, v86, v56, v58
  v_dot2_f32_bf16 v59, v79, v49, v59
  v_dot2_f32_bf16 v58, v83, v53, v58
  v_dot2_f32_bf16 v59, v87, v57, v59
  s_nop 2
  v_add_f32 v58, v58, v59
  s_nop 1
  v_add_f32_dpp v58, v58, v58 quad_perm:[1,0,3,2] row_mask:0xf bank_mask:0xf
  s_nop 1
  v_add_f32_dpp v58, v58, v58 quad_perm:[2,3,0,1] row_mask:0xf bank_mask:0xf
  s_nop 1
  v_add_f32_dpp v58, v58, v58 row_half_mirror row_mask:0xf bank_mask:0xf
  v_cndmask_b32 v44, v44, v58, s[62:63]
  s_lshr_b32 s46, s42, 1
  s_lshl_b32 s46, s46, 4
  s_and_b32 s47, s42, 1
  s_add_u32 s48, s46, s47
  s_add_u32 s48, s48, s43
  s_and_b32 s48, s48, 511
  s_mul_i32 s48, s48, 3072
  s_add_u32 s42, s42, 1
  s_and_b32 s42, s42, 63
  s_waitcnt vmcnt(0)
  buffer_load_dwordx4 v[100:103], v2, s[4:7], s48 offen offset:0 nt
  buffer_load_dwordx4 v[104:107], v2, s[4:7], s48 offen offset:128 nt
  buffer_load_dwordx4 v[108:111], v2, s[4:7], s48 offen offset:256 nt
  v_dot2_f32_bf16 v58, v88, v46, 0
  v_dot2_f32_bf16 v59, v92, v50, 0
  v_dot2_f32_bf16 v58, v96, v54, v58
  v_dot2_f32_bf16 v59, v89, v47, v59
  v_dot2_f32_bf16 v58, v93, v51, v58
  v_dot2_f32_bf16 v59, v97, v55, v59
  v_dot2_f32_bf16 v58, v90, v48, v58
  v_dot2_f32_bf16 v59, v94, v52, v59
  v_dot2_f32_bf16 v58, v98, v56, v58
  v_dot2_f32_bf16 v59, v91, v49, v59
  v_dot2_f32_bf16 v58, v95, v53, v58
  v_dot2_f32_bf16 v59, v99, v57, v59
  s_nop 2
  v_add_f32 v58, v58, v59
  s_nop 1
  v_add_f32_dpp v58, v58, v58 quad_perm:[1,0,3,2] row_mask:0xf bank_mask:0xf
  s_nop 1
  v_add_f32_dpp v58, v58, v58 quad_perm:[2,3,0,1] row_mask:0xf bank_mask:0xf
  s_nop 1
  v_add_f32_dpp v58, v58, v58 row_half_mirror row_mask:0xf bank_mask:0xf
  v_cndmask_b32 v44, v44, v58, s[64:65]
  buffer_load_dwordx4 v[128:131], v5, s[16:19], s49 offen offset:1024
  s_lshr_b32 s46, s42, 1
  s_lshl_b32 s46, s46, 4
  s_and_b32 s47, s42, 1
  s_add_u32 s48, s46, s47
  s_add_u32 s48, s48, s43
  s_and_b32 s48, s48, 511
  s_mul_i32 s48, s48, 3072
  s_add_u32 s42, s42, 1
  s_and_b32 s42, s42, 63
  s_waitcnt vmcnt(1)
  buffer_load_dwordx4 v[64:67], v2, s[4:7], s48 offen offset:0 nt
  buffer_load_dwordx4 v[68:71], v2, s[4:7], s48 offen offset:128 nt
  buffer_load_dwordx4 v[72:75], v2, s[4:7], s48 offen offset:256 nt
  v_dot2_f32_bf16 v58, v100, v46, 0
  v_dot2_f32_bf16 v59, v104, v50, 0
  v_dot2_f32_bf16 v58, v108, v54, v58
  v_dot2_f32_bf16 v59, v101, v47, v59
  v_dot2_f32_bf16 v58, v105, v51, v58
  v_dot2_f32_bf16 v59, v109, v55, v59
  v_dot2_f32_bf16 v58, v102, v48, v58
  v_dot2_f32_bf16 v59, v106, v52, v59
  v_dot2_f32_bf16 v58, v110, v56, v58
  v_dot2_f32_bf16 v59, v103, v49, v59
  v_dot2_f32_bf16 v58, v107, v53, v58
  v_dot2_f32_bf16 v59, v111, v57, v59
  s_nop 2
  v_add_f32 v58, v58, v59
  s_nop 1
  v_add_f32_dpp v58, v58, v58 quad_perm:[1,0,3,2] row_mask:0xf bank_mask:0xf
  s_nop 1
  v_add_f32_dpp v58, v58, v58 quad_perm:[2,3,0,1] row_mask:0xf bank_mask:0xf
  s_nop 1
  v_add_f32_dpp v58, v58, v58 row_half_mirror row_mask:0xf bank_mask:0xf
  v_cndmask_b32 v44, v44, v58, s[66:67]
  s_lshr_b32 s46, s42, 1
  s_lshl_b32 s46, s46, 4
  s_and_b32 s47, s42, 1
  s_add_u32 s48, s46, s47
  s_add_u32 s48, s48, s43
  s_and_b32 s48, s48, 511
  s_mul_i32 s48, s48, 3072
  s_add_u32 s42, s42, 1
  s_and_b32 s42, s42, 63
  s_waitcnt vmcnt(0)
  buffer_load_dwordx4 v[76:79], v2, s[4:7], s48 offen offset:0 nt
  buffer_load_dwordx4 v[80:83], v2, s[4:7], s48 offen offset:128 nt
  buffer_load_dwordx4 v[84:87], v2, s[4:7], s48 offen offset:256 nt
  v_dot2_f32_bf16 v58, v64, v46, 0
  v_dot2_f32_bf16 v59, v68, v50, 0
  v_dot2_f32_bf16 v58, v72, v54, v58
  v_dot2_f32_bf16 v59, v65, v47, v59
  v_dot2_f32_bf16 v58, v69, v51, v58
  v_dot2_f32_bf16 v59, v73, v55, v59
  v_dot2_f32_bf16 v58, v66, v48, v58
  v_dot2_f32_bf16 v59, v70, v52, v59
  v_dot2_f32_bf16 v58, v74, v56, v58
  v_dot2_f32_bf16 v59, v67, v49, v59
  v_dot2_f32_bf16 v58, v71, v53, v58
  v_dot2_f32_bf16 v59, v75, v57, v59
  s_nop 2
  v_add_f32 v58, v58, v59
  s_nop 1
  v_add_f32_dpp v58, v58, v58 quad_perm:[1,0,3,2] row_mask:0xf bank_mask:0xf
  s_nop 1
  v_add_f32_dpp v58, v58, v58 quad_perm:[2,3,0,1] row_mask:0xf bank_mask:0xf
  s_nop 1
  v_add_f32_dpp v58, v58, v58 row_half_mirror row_mask:0xf bank_mask:0xf
  v_mov_b32 v45, v58
  s_add_u32 s49, s49, 5120
  buffer_load_dwordx4 v[132:135], v5, s[16:19], s49 offen offset:0
  s_lshr_b32 s46, s42, 1
  s_lshl_b32 s46, s46, 4
  s_and_b32 s47, s42, 1
  s_add_u32 s48, s46, s47
  s_add_u32 s48, s48, s43
  s_and_b32 s48, s48, 511
  s_mul_i32 s48, s48, 3072
  s_add_u32 s42, s42, 1
  s_and_b32 s42, s42, 63
  s_waitcnt vmcnt(1)
  buffer_load_dwordx4 v[88:91], v2, s[4:7], s48 offen offset:0 nt
  buffer_load_dwordx4 v[92:95], v2, s[4:7], s48 offen offset:128 nt
  buffer_load_dwordx4 v[96:99], v2, s[4:7], s48 offen offset:256 nt
  v_dot2_f32_bf16 v58, v76, v46, 0
  v_dot2_f32_bf16 v59, v80, v50, 0
  v_dot2_f32_bf16 v58, v84, v54, v58
  v_dot2_f32_bf16 v59, v77, v47, v59
  v_dot2_f32_bf16 v58, v81, v51, v58
  v_dot2_f32_bf16 v59, v85, v55, v59
  v_dot2_f32_bf16 v58, v78, v48, v58
  v_dot2_f32_bf16 v59, v82, v52, v59
  v_dot2_f32_bf16 v58, v86, v56, v58
  v_dot2_f32_bf16 v59, v79, v49, v59
  v_dot2_f32_bf16 v58, v83, v53, v58
  v_dot2_f32_bf16 v59, v87, v57, v59
  s_nop 2
  v_add_f32 v58, v58, v59
  s_nop 1
  v_add_f32_dpp v58, v58, v58 quad_perm:[1,0,3,2] row_mask:0xf bank_mask:0xf
  s_nop 1
  v_add_f32_dpp v58, v58, v58 quad_perm:[2,3,0,1] row_mask:0xf bank_mask:0xf
  s_nop 1
  v_add_f32_dpp v58, v58, v58 row_half_mirror row_mask:0xf bank_mask:0xf
  v_cndmask_b32 v45, v45, v58, s[54:55]
  s_lshr_b32 s46, s42, 1
  s_lshl_b32 s46, s46, 4
  s_and_b32 s47, s42, 1
  s_add_u32 s48, s46, s47
  s_add_u32 s48, s48, s43
  s_and_b32 s48, s48, 511
  s_mul_i32 s48, s48, 3072
  s_add_u32 s42, s42, 1
  s_and_b32 s42, s42, 63
  s_waitcnt vmcnt(0)
  buffer_load_dwordx4 v[100:103], v2, s[4:7], s48 offen offset:0 nt
  buffer_load_dwordx4 v[104:107], v2, s[4:7], s48 offen offset:128 nt
  buffer_load_dwordx4 v[108:111], v2, s[4:7], s48 offen offset:256 nt
  v_dot2_f32_bf16 v58, v88, v46, 0
  v_dot2_f32_bf16 v59, v92, v50, 0
  v_dot2_f32_bf16 v58, v96, v54, v58
  v_dot2_f32_bf16 v59, v89, v47, v59
  v_dot2_f32_bf16 v58, v93, v51, v58
  v_dot2_f32_bf16 v59, v97, v55, v59
  v_dot2_f32_bf16 v58, v90, v48, v58
  v_dot2_f32_bf16 v59, v94, v52, v59
  v_dot2_f32_bf16 v58, v98, v56, v58
  v_dot2_f32_bf16 v59, v91, v49, v59
  v_dot2_f32_bf16 v58, v95, v53, v58
  v_dot2_f32_bf16 v59, v99, v57, v59
  s_nop 2
  v_add_f32 v58, v58, v59
  s_nop 1
  v_add_f32_dpp v58, v58, v58 quad_perm:[1,0,3,2] row_mask:0xf bank_mask:0xf
  s_nop 1
  v_add_f32_dpp v58, v58, v58 quad_perm:[2,3,0,1] row_mask:0xf bank_mask:0xf
  s_nop 1
  v_add_f32_dpp v58, v58, v58 row_half_mirror row_mask:0xf bank_mask:0xf
  v_cndmask_b32 v45, v45, v58, s[56:57]
  buffer_load_dwordx4 v[136:139], v5, s[16:19], s49 offen offset:256
  s_lshr_b32 s46, s42, 1
  s_lshl_b32 s46, s46, 4
  s_and_b32 s47, s42, 1
  s_add_u32 s48, s46, s47
  s_add_u32 s48, s48, s43
  s_and_b32 s48, s48, 511
  s_mul_i32 s48, s48, 3072
  s_add_u32 s42, s42, 1
  s_and_b32 s42, s42, 63
  s_waitcnt vmcnt(1)
  buffer_load_dwordx4 v[64:67], v2, s[4:7], s48 offen offset:0 nt
  buffer_load_dwordx4 v[68:71], v2, s[4:7], s48 offen offset:128 nt
  buffer_load_dwordx4 v[72:75], v2, s[4:7], s48 offen offset:256 nt
  v_dot2_f32_bf16 v58, v100, v46, 0
  v_dot2_f32_bf16 v59, v104, v50, 0
  v_dot2_f32_bf16 v58, v108, v54, v58
  v_dot2_f32_bf16 v59, v101, v47, v59
  v_dot2_f32_bf16 v58, v105, v51, v58
  v_dot2_f32_bf16 v59, v109, v55, v59
  v_dot2_f32_bf16 v58, v102, v48, v58
  v_dot2_f32_bf16 v59, v106, v52, v59
  v_dot2_f32_bf16 v58, v110, v56, v58
  v_dot2_f32_bf16 v59, v103, v49, v59
  v_dot2_f32_bf16 v58, v107, v53, v58
  v_dot2_f32_bf16 v59, v111, v57, v59
  s_nop 2
  v_add_f32 v58, v58, v59
  s_nop 1
  v_add_f32_dpp v58, v58, v58 quad_perm:[1,0,3,2] row_mask:0xf bank_mask:0xf
  s_nop 1
  v_add_f32_dpp v58, v58, v58 quad_perm:[2,3,0,1] row_mask:0xf bank_mask:0xf
  s_nop 1
  v_add_f32_dpp v58, v58, v58 row_half_mirror row_mask:0xf bank_mask:0xf
  v_cndmask_b32 v45, v45, v58, s[58:59]
  s_lshr_b32 s46, s42, 1
  s_lshl_b32 s46, s46, 4
  s_and_b32 s47, s42, 1
  s_add_u32 s48, s46, s47
  s_add_u32 s48, s48, s43
  s_and_b32 s48, s48, 511
  s_mul_i32 s48, s48, 3072
  s_add_u32 s42, s42, 1
  s_and_b32 s42, s42, 63
  s_waitcnt vmcnt(0)
  buffer_load_dwordx4 v[76:79], v2, s[4:7], s48 offen offset:0 nt
  buffer_load_dwordx4 v[80:83], v2, s[4:7], s48 offen offset:128 nt
  buffer_load_dwordx4 v[84:87], v2, s[4:7], s48 offen offset:256 nt
  v_dot2_f32_bf16 v58, v64, v46, 0
  v_dot2_f32_bf16 v59, v68, v50, 0
  v_dot2_f32_bf16 v58, v72, v54, v58
  v_dot2_f32_bf16 v59, v65, v47, v59
  v_dot2_f32_bf16 v58, v69, v51, v58
  v_dot2_f32_bf16 v59, v73, v55, v59
  v_dot2_f32_bf16 v58, v66, v48, v58
  v_dot2_f32_bf16 v59, v70, v52, v59
  v_dot2_f32_bf16 v58, v74, v56, v58
  v_dot2_f32_bf16 v59, v67, v49, v59
  v_dot2_f32_bf16 v58, v71, v53, v58
  v_dot2_f32_bf16 v59, v75, v57, v59
  s_nop 2
  v_add_f32 v58, v58, v59
  s_nop 1
  v_add_f32_dpp v58, v58, v58 quad_perm:[1,0,3,2] row_mask:0xf bank_mask:0xf
  s_nop 1
  v_add_f32_dpp v58, v58, v58 quad_perm:[2,3,0,1] row_mask:0xf bank_mask:0xf
  s_nop 1
  v_add_f32_dpp v58, v58, v58 row_half_mirror row_mask:0xf bank_mask:0xf
  v_cndmask_b32 v45, v45, v58, s[60:61]
  buffer_load_dwordx4 v[140:143], v5, s[16:19], s49 offen offset:512
  s_lshr_b32 s46, s42, 1
  s_lshl_b32 s46, s46, 4
  s_and_b32 s47, s42, 1
  s_add_u32 s48, s46, s47
  s_add_u32 s48, s48, s43
  s_and_b32 s48, s48, 511
  s_mul_i32 s48, s48, 3072
  s_add_u32 s42, s42, 1
  s_and_b32 s42, s42, 63
  s_waitcnt vmcnt(1)
  buffer_load_dwordx4 v[88:91], v2, s[4:7], s48 offen offset:0 nt
  buffer_load_dwordx4 v[92:95], v2, s[4:7], s48 offen offset:128 nt
  buffer_load_dwordx4 v[96:99], v2, s[4:7], s48 offen offset:256 nt
  v_dot2_f32_bf16 v58, v76, v46, 0
  v_dot2_f32_bf16 v59, v80, v50, 0
  v_dot2_f32_bf16 v58, v84, v54, v58
  v_dot2_f32_bf16 v59, v77, v47, v59
  v_dot2_f32_bf16 v58, v81, v51, v58
  v_dot2_f32_bf16 v59, v85, v55, v59
  v_dot2_f32_bf16 v58, v78, v48, v58
  v_dot2_f32_bf16 v59, v82, v52, v59
  v_dot2_f32_bf16 v58, v86, v56, v58
  v_dot2_f32_bf16 v59, v79, v49, v59
  v_dot2_f32_bf16 v58, v83, v53, v58
  v_dot2_f32_bf16 v59, v87, v57, v59
  s_nop 2
  v_add_f32 v58, v58, v59
  s_nop 1
  v_add_f32_dpp v58, v58, v58 quad_perm:[1,0,3,2] row_mask:0xf bank_mask:0xf
  s_nop 1
  v_add_f32_dpp v58, v58, v58 quad_perm:[2,3,0,1] row_mask:0xf bank_mask:0xf
  s_nop 1
  v_add_f32_dpp v58, v58, v58 row_half_mirror row_mask:0xf bank_mask:0xf
  v_cndmask_b32 v45, v45, v58, s[62:63]
  s_lshr_b32 s46, s42, 1
  s_lshl_b32 s46, s46, 4
  s_and_b32 s47, s42, 1
  s_add_u32 s48, s46, s47
  s_add_u32 s48, s48, s43
  s_and_b32 s48, s48, 511
  s_mul_i32 s48, s48, 3072
  s_add_u32 s42, s42, 1
  s_and_b32 s42, s42, 63
  s_waitcnt vmcnt(0)
  buffer_load_dwordx4 v[100:103], v2, s[4:7], s48 offen offset:0 nt
  buffer_load_dwordx4 v[104:107], v2, s[4:7], s48 offen offset:128 nt
  buffer_load_dwordx4 v[108:111], v2, s[4:7], s48 offen offset:256 nt
  v_dot2_f32_bf16 v58, v88, v46, 0
  v_dot2_f32_bf16 v59, v92, v50, 0
  v_dot2_f32_bf16 v58, v96, v54, v58
  v_dot2_f32_bf16 v59, v89, v47, v59
  v_dot2_f32_bf16 v58, v93, v51, v58
  v_dot2_f32_bf16 v59, v97, v55, v59
  v_dot2_f32_bf16 v58, v90, v48, v58
  v_dot2_f32_bf16 v59, v94, v52, v59
  v_dot2_f32_bf16 v58, v98, v56, v58
  v_dot2_f32_bf16 v59, v91, v49, v59
  v_dot2_f32_bf16 v58, v95, v53, v58
  v_dot2_f32_bf16 v59, v99, v57, v59
  s_nop 2
  v_add_f32 v58, v58, v59
  s_nop 1
  v_add_f32_dpp v58, v58, v58 quad_perm:[1,0,3,2] row_mask:0xf bank_mask:0xf
  s_nop 1
  v_add_f32_dpp v58, v58, v58 quad_perm:[2,3,0,1] row_mask:0xf bank_mask:0xf
  s_nop 1
  v_add_f32_dpp v58, v58, v58 row_half_mirror row_mask:0xf bank_mask:0xf
  v_cndmask_b32 v45, v45, v58, s[64:65]
  buffer_load_dwordx4 v[144:147], v5, s[16:19], s49 offen offset:768
  s_lshr_b32 s46, s42, 1
  s_lshl_b32 s46, s46, 4
  s_and_b32 s47, s42, 1
  s_add_u32 s48, s46, s47
  s_add_u32 s48, s48, s43
  s_and_b32 s48, s48, 511
  s_mul_i32 s48, s48, 3072
  s_add_u32 s42, s42, 1
  s_and_b32 s42, s42, 63
  s_waitcnt vmcnt(1)
  buffer_load_dwordx4 v[64:67], v2, s[8:11], s48 offen offset:0 nt
  buffer_load_dwordx4 v[68:71], v2, s[8:11], s48 offen offset:128 nt
  buffer_load_dwordx4 v[72:75], v2, s[8:11], s48 offen offset:256 nt
  v_dot2_f32_bf16 v58, v100, v46, 0
  v_dot2_f32_bf16 v59, v104, v50, 0
  v_dot2_f32_bf16 v58, v108, v54, v58
  v_dot2_f32_bf16 v59, v101, v47, v59
  v_dot2_f32_bf16 v58, v105, v51, v58
  v_dot2_f32_bf16 v59, v109, v55, v59
  v_dot2_f32_bf16 v58, v102, v48, v58
  v_dot2_f32_bf16 v59, v106, v52, v59
  v_dot2_f32_bf16 v58, v110, v56, v58
  v_dot2_f32_bf16 v59, v103, v49, v59
  v_dot2_f32_bf16 v58, v107, v53, v58
  v_dot2_f32_bf16 v59, v111, v57, v59
  s_nop 2
  v_add_f32 v58, v58, v59
  s_nop 1
  v_add_f32_dpp v58, v58, v58 quad_perm:[1,0,3,2] row_mask:0xf bank_mask:0xf
  s_nop 1
  v_add_f32_dpp v58, v58, v58 quad_perm:[2,3,0,1] row_mask:0xf bank_mask:0xf
  s_nop 1
  v_add_f32_dpp v58, v58, v58 row_half_mirror row_mask:0xf bank_mask:0xf
  v_cndmask_b32 v45, v45, v58, s[66:67]
  v_cvt_pk_bf16_f32 v38, v38, v38
  v_and_b32 v38, 0xffff0000, v38
  v_cvt_pk_bf16_f32 v39, v39, v39
  v_and_b32 v39, 0xffff0000, v39
  v_cvt_pk_bf16_f32 v40, v40, v40
  v_and_b32 v40, 0xffff0000, v40
  v_cvt_pk_bf16_f32 v41, v41, v41
  v_and_b32 v41, 0xffff0000, v41
  v_cvt_pk_bf16_f32 v42, v42, v42
  v_and_b32 v42, 0xffff0000, v42
  v_cvt_pk_bf16_f32 v43, v43, v43
  v_and_b32 v43, 0xffff0000, v43
  v_cvt_pk_bf16_f32 v44, v44, v44
  v_and_b32 v44, 0xffff0000, v44
  v_cvt_pk_bf16_f32 v45, v45, v45
  v_and_b32 v45, 0xffff0000, v45
  v_mul_f32 v38, 0x3d93cd3a, v38
  v_mul_f32 v39, 0x3d93cd3a, v39
  v_mul_f32 v40, 0x3d93cd3a, v40
  v_mul_f32 v41, 0x3d93cd3a, v41
  v_mul_f32 v42, 0x3d93cd3a, v42
  v_mul_f32 v43, 0x3d93cd3a, v43
  v_mul_f32 v44, 0x3d93cd3a, v44
  v_mul_f32 v45, 0x3d93cd3a, v45
  v_cvt_pk_bf16_f32 v38, v38, v38
  v_and_b32 v38, 0xffff0000, v38
  v_cvt_pk_bf16_f32 v39, v39, v39
  v_and_b32 v39, 0xffff0000, v39
  v_cvt_pk_bf16_f32 v40, v40, v40
  v_and_b32 v40, 0xffff0000, v40
  v_cvt_pk_bf16_f32 v41, v41, v41
  v_and_b32 v41, 0xffff0000, v41
  v_cvt_pk_bf16_f32 v42, v42, v42
  v_and_b32 v42, 0xffff0000, v42
  v_cvt_pk_bf16_f32 v43, v43, v43
  v_and_b32 v43, 0xffff0000, v43
  v_cvt_pk_bf16_f32 v44, v44, v44
  v_and_b32 v44, 0xffff0000, v44
  v_cvt_pk_bf16_f32 v45, v45, v45
  v_and_b32 v45, 0xffff0000, v45
  v_max3_f32 v58, v38, v39, v40
  v_max3_f32 v58, v58, v41, v42
  v_max3_f32 v58, v58, v43, v44
  v_max_f32 v58, v58, v45
  s_nop 1
  v_max_f32_dpp v58, v58, v58 row_ror:8 row_mask:0xf bank_mask:0xf
  s_nop 1
  v_max_f32_dpp v58, v58, v58 row_ror:4 row_mask:0xf bank_mask:0xf
  s_nop 1
  v_max_f32_dpp v58, v58, v58 row_ror:2 row_mask:0xf bank_mask:0xf
  s_nop 1
  v_max_f32_dpp v58, v58, v58 row_ror:1 row_mask:0xf bank_mask:0xf
  v_mov_b32 v59, v58
  s_nop 1
  v_permlane16_swap_b32 v58, v59
  s_nop 0
  v_max_f32 v58, v58, v59
  v_mov_b32 v59, v58
  s_nop 1
  v_permlane32_swap_b32 v58, v59
  s_nop 0
  v_max_f32 v58, v58, v59
  v_sub_f32 v38, v38, v58
  v_sub_f32 v39, v39, v58
  v_sub_f32 v40, v40, v58
  v_sub_f32 v41, v41, v58
  v_sub_f32 v42, v42, v58
  v_sub_f32 v43, v43, v58
  v_sub_f32 v44, v44, v58
  v_sub_f32 v45, v45, v58
  v_mul_f32 v38, 0x3fb8aa3b, v38
  v_mul_f32 v39, 0x3fb8aa3b, v39
  v_mul_f32 v40, 0x3fb8aa3b, v40
  v_mul_f32 v41, 0x3fb8aa3b, v41
  v_mul_f32 v42, 0x3fb8aa3b, v42
  v_mul_f32 v43, 0x3fb8aa3b, v43
  v_mul_f32 v44, 0x3fb8aa3b, v44
  v_mul_f32 v45, 0x3fb8aa3b, v45
  v_exp_f32 v38, v38
  v_exp_f32 v39, v39
  v_exp_f32 v40, v40
  v_exp_f32 v41, v41
  v_exp_f32 v42, v42
  v_exp_f32 v43, v43
  v_exp_f32 v44, v44
  v_exp_f32 v45, v45
  s_nop 0
  v_add_f32 v59, v38, v39
  v_add_f32 v59, v59, v40
  v_add_f32 v59, v59, v41
  v_add_f32 v59, v59, v42
  v_add_f32 v59, v59, v43
  v_add_f32 v59, v59, v44
  v_add_f32 v59, v59, v45
  v_cvt_pk_bf16_f32 v38, v38, v38
  v_cvt_pk_bf16_f32 v39, v39, v39
  v_cvt_pk_bf16_f32 v40, v40, v40
  v_cvt_pk_bf16_f32 v41, v41, v41
  v_cvt_pk_bf16_f32 v42, v42, v42
  v_cvt_pk_bf16_f32 v43, v43, v43
  v_cvt_pk_bf16_f32 v44, v44, v44
  v_cvt_pk_bf16_f32 v45, v45, v45
  v_lshlrev_b32 v60, 2, v1
  s_lshl_b32 s44, s3, 11
  v_add_u32 v60, s44, v60
  ds_write_b32 v60, v38 offset:19712
  ds_write_b32 v60, v39 offset:19968
  ds_write_b32 v60, v40 offset:20224
  ds_write_b32 v60, v41 offset:20480
  ds_write_b32 v60, v42 offset:20736
  ds_write_b32 v60, v43 offset:20992
  ds_write_b32 v60, v44 offset:21248
  ds_write_b32 v60, v45 offset:21504
  s_nop 1
  v_add_f32_dpp v59, v59, v59 row_ror:8 row_mask:0xf bank_mask:0xf
  s_nop 1
  v_add_f32_dpp v59, v59, v59 row_ror:4 row_mask:0xf bank_mask:0xf
  s_nop 1
  v_add_f32_dpp v59, v59, v59 row_ror:2 row_mask:0xf bank_mask:0xf
  s_nop 1
  v_add_f32_dpp v59, v59, v59 row_ror:1 row_mask:0xf bank_mask:0xf
  v_mov_b32 v61, v59
  s_nop 1
  v_permlane16_swap_b32 v59, v61
  s_nop 0
  v_add_f32 v59, v59, v61
  v_mov_b32 v61, v59
  s_nop 1
  v_permlane32_swap_b32 v59, v61
  s_nop 0
  v_add_f32 v59, v59, v61
  s_lshl_b32 s44, s3, 3
  v_mov_b32 v61, s44
  ds_write_b64 v61, v[58:59] offset:19584
  v_and_b32 v60, 0x38, v1
  v_lshlrev_b32 v60, 2, v60
  s_lshl_b32 s44, s3, 11
  v_add_u32 v60, s44, v60
  s_waitcnt lgkmcnt(0)
  ds_read_b128 v[38:41], v60 offset:19712
  ds_read_b128 v[42:45], v60 offset:19728
  s_waitcnt lgkmcnt(0)
  v_and_b32 v14, v38, v6
  v_and_b32 v15, v38, v7
  v_and_b32 v16, v38, v8
  v_and_b32 v17, v38, v9
  s_lshr_b32 s46, s42, 1
  s_lshl_b32 s46, s46, 4
  s_and_b32 s47, s42, 1
  s_add_u32 s48, s46, s47
  s_add_u32 s48, s48, s43
  s_and_b32 s48, s48, 511
  s_mul_i32 s48, s48, 3072
  s_add_u32 s42, s42, 1
  s_and_b32 s42, s42, 63
  s_waitcnt vmcnt(0)
  buffer_load_dwordx4 v[76:79], v2, s[8:11], s48 offen offset:0 nt
  buffer_load_dwordx4 v[80:83], v2, s[8:11], s48 offen offset:128 nt
  buffer_load_dwordx4 v[84:87], v2, s[8:11], s48 offen offset:256 nt
  buffer_load_dwordx4 v[148:151], v5, s[16:19], s49 offen offset:1024
  s_nop 0
  v_mfma_f32_16x16x32_bf16 v[22:25], v[14:17], v[64:67], 0
  v_mfma_f32_16x16x32_bf16 v[26:29], v[14:17], v[68:71], 0
  v_mfma_f32_16x16x32_bf16 v[30:33], v[14:17], v[72:75], 0
  ds_read_b128 v[46:49], v60 offset:19968
  ds_read_b128 v[50:53], v60 offset:19984
  v_and_b32 v18, v39, v6
  v_and_b32 v19, v39, v7
  v_and_b32 v20, v39, v8
  v_and_b32 v21, v39, v9
  s_lshr_b32 s46, s42, 1
  s_lshl_b32 s46, s46, 4
  s_and_b32 s47, s42, 1
  s_add_u32 s48, s46, s47
  s_add_u32 s48, s48, s43
  s_and_b32 s48, s48, 511
  s_mul_i32 s48, s48, 3072
  s_add_u32 s42, s42, 1
  s_and_b32 s42, s42, 63
  s_waitcnt vmcnt(1)
  buffer_load_dwordx4 v[88:91], v2, s[8:11], s48 offen offset:0 nt
  buffer_load_dwordx4 v[92:95], v2, s[8:11], s48 offen offset:128 nt
  buffer_load_dwordx4 v[96:99], v2, s[8:11], s48 offen offset:256 nt
  s_nop 0
  v_mfma_f32_16x16x32_bf16 v[22:25], v[18:21], v[76:79], v[22:25]
  v_mfma_f32_16x16x32_bf16 v[26:29], v[18:21], v[80:83], v[26:29]
  v_mfma_f32_16x16x32_bf16 v[30:33], v[18:21], v[84:87], v[30:33]
  v_and_b32 v14, v40, v6
  v_and_b32 v15, v40, v7
  v_and_b32 v16, v40, v8
  v_and_b32 v17, v40, v9
  s_lshr_b32 s46, s42, 1
  s_lshl_b32 s46, s46, 4
  s_and_b32 s47, s42, 1
  s_add_u32 s48, s46, s47
  s_add_u32 s48, s48, s43
  s_and_b32 s48, s48, 511
  s_mul_i32 s48, s48, 3072
  s_add_u32 s42, s42, 1
  s_and_b32 s42, s42, 63
  s_waitcnt vmcnt(0)
  buffer_load_dwordx4 v[100:103], v2, s[8:11], s48 offen offset:0 nt
  buffer_load_dwordx4 v[104:107], v2, s[8:11], s48 offen offset:128 nt
  buffer_load_dwordx4 v[108:111], v2, s[8:11], s48 offen offset:256 nt
  s_add_u32 s49, s49, 5120
  buffer_load_dwordx4 v[152:155], v5, s[16:19], s49 offen offset:0
  s_nop 0
  v_mfma_f32_16x16x32_bf16 v[22:25], v[14:17], v[88:91], v[22:25]
  v_mfma_f32_16x16x32_bf16 v[26:29], v[14:17], v[92:95], v[26:29]
  v_mfma_f32_16x16x32_bf16 v[30:33], v[14:17], v[96:99], v[30:33]
  v_and_b32 v18, v41, v6
  v_and_b32 v19, v41, v7
  v_and_b32 v20, v41, v8
  v_and_b32 v21, v41, v9
  s_lshr_b32 s46, s42, 1
  s_lshl_b32 s46, s46, 4
  s_and_b32 s47, s42, 1
  s_add_u32 s48, s46, s47
  s_add_u32 s48, s48, s43
  s_and_b32 s48, s48, 511
  s_mul_i32 s48, s48, 3072
  s_add_u32 s42, s42, 1
  s_and_b32 s42, s42, 63
  s_waitcnt vmcnt(1)
  buffer_load_dwordx4 v[64:67], v2, s[8:11], s48 offen offset:0 nt
  buffer_load_dwordx4 v[68:71], v2, s[8:11], s48 offen offset:128 nt
  buffer_load_dwordx4 v[72:75], v2, s[8:11], s48 offen offset:256 nt
  s_nop 0
  v_mfma_f32_16x16x32_bf16 v[22:25], v[18:21], v[100:103], v[22:25]
  v_mfma_f32_16x16x32_bf16 v[26:29], v[18:21], v[104:107], v[26:29]
  v_mfma_f32_16x16x32_bf16 v[30:33], v[18:21], v[108:111], v[30:33]
  v_and_b32 v14, v42, v6
  v_and_b32 v15, v42, v7
  v_and_b32 v16, v42, v8
  v_and_b32 v17, v42, v9
  s_lshr_b32 s46, s42, 1
  s_lshl_b32 s46, s46, 4
  s_and_b32 s47, s42, 1
  s_add_u32 s48, s46, s47
  s_add_u32 s48, s48, s43
  s_and_b32 s48, s48, 511
  s_mul_i32 s48, s48, 3072
  s_add_u32 s42, s42, 1
  s_and_b32 s42, s42, 63
  s_waitcnt vmcnt(0)
  buffer_load_dwordx4 v[76:79], v2, s[8:11], s48 offen offset:0 nt
  buffer_load_dwordx4 v[80:83], v2, s[8:11], s48 offen offset:128 nt
  buffer_load_dwordx4 v[84:87], v2, s[8:11], s48 offen offset:256 nt
  buffer_load_dwordx4 v[156:159], v5, s[16:19], s49 offen offset:256
  s_nop 0
  v_mfma_f32_16x16x32_bf16 v[22:25], v[14:17], v[64:67], v[22:25]
  v_mfma_f32_16x16x32_bf16 v[26:29], v[14:17], v[68:71], v[26:29]
  v_mfma_f32_16x16x32_bf16 v[30:33], v[14:17], v[72:75], v[30:33]
  v_and_b32 v18, v43, v6
  v_and_b32 v19, v43, v7
  v_and_b32 v20, v43, v8
  v_and_b32 v21, v43, v9
  s_lshr_b32 s46, s42, 1
  s_lshl_b32 s46, s46, 4
  s_and_b32 s47, s42, 1
  s_add_u32 s48, s46, s47
  s_add_u32 s48, s48, s43
  s_and_b32 s48, s48, 511
  s_mul_i32 s48, s48, 3072
  s_add_u32 s42, s42, 1
  s_and_b32 s42, s42, 63
  s_waitcnt vmcnt(1)
  buffer_load_dwordx4 v[88:91], v2, s[8:11], s48 offen offset:0 nt
  buffer_load_dwordx4 v[92:95], v2, s[8:11], s48 offen offset:128 nt
  buffer_load_dwordx4 v[96:99], v2, s[8:11], s48 offen offset:256 nt
  s_nop 0
  v_mfma_f32_16x16x32_bf16 v[22:25], v[18:21], v[76:79], v[22:25]
  v_mfma_f32_16x16x32_bf16 v[26:29], v[18:21], v[80:83], v[26:29]
  v_mfma_f32_16x16x32_bf16 v[30:33], v[18:21], v[84:87], v[30:33]
  v_and_b32 v14, v44, v6
  v_and_b32 v15, v44, v7
  v_and_b32 v16, v44, v8
  v_and_b32 v17, v44, v9
  s_lshr_b32 s46, s42, 1
  s_lshl_b32 s46, s46, 4
  s_and_b32 s47, s42, 1
  s_add_u32 s48, s46, s47
  s_add_u32 s48, s48, s43
  s_and_b32 s48, s48, 511
  s_mul_i32 s48, s48, 3072
  s_add_u32 s42, s42, 1
  s_and_b32 s42, s42, 63
  s_waitcnt vmcnt(0)
  buffer_load_dwordx4 v[100:103], v2, s[8:11], s48 offen offset:0 nt
  buffer_load_dwordx4 v[104:107], v2, s[8:11], s48 offen offset:128 nt
  buffer_load_dwordx4 v[108:111], v2, s[8:11], s48 offen offset:256 nt
  buffer_load_dwordx4 v[160:163], v5, s[16:19], s49 offen offset:512
  s_nop 0
  v_mfma_f32_16x16x32_bf16 v[22:25], v[14:17], v[88:91], v[22:25]
  v_mfma_f32_16x16x32_bf16 v[26:29], v[14:17], v[92:95], v[26:29]
  v_mfma_f32_16x16x32_bf16 v[30:33], v[14:17], v[96:99], v[30:33]
  v_and_b32 v18, v45, v6
  v_and_b32 v19, v45, v7
  v_and_b32 v20, v45, v8
  v_and_b32 v21, v45, v9
  s_lshr_b32 s46, s42, 1
  s_lshl_b32 s46, s46, 4
  s_and_b32 s47, s42, 1
  s_add_u32 s48, s46, s47
  s_add_u32 s48, s48, s43
  s_and_b32 s48, s48, 511
  s_mul_i32 s48, s48, 3072
  s_add_u32 s42, s42, 1
  s_and_b32 s42, s42, 63
  s_waitcnt vmcnt(1)
  buffer_load_dwordx4 v[64:67], v2, s[8:11], s48 offen offset:0 nt
  buffer_load_dwordx4 v[68:71], v2, s[8:11], s48 offen offset:128 nt
  buffer_load_dwordx4 v[72:75], v2, s[8:11], s48 offen offset:256 nt
  s_nop 0
  v_mfma_f32_16x16x32_bf16 v[22:25], v[18:21], v[100:103], v[22:25]
  v_mfma_f32_16x16x32_bf16 v[26:29], v[18:21], v[104:107], v[26:29]
  v_mfma_f32_16x16x32_bf16 v[30:33], v[18:21], v[108:111], v[30:33]
  s_waitcnt lgkmcnt(0)
  v_and_b32 v14, v46, v6
  v_and_b32 v15, v46, v7
  v_and_b32 v16, v46, v8
  v_and_b32 v17, v46, v9
  s_lshr_b32 s46, s42, 1
  s_lshl_b32 s46, s46, 4
  s_and_b32 s47, s42, 1
  s_add_u32 s48, s46, s47
  s_add_u32 s48, s48, s43
  s_and_b32 s48, s48, 511
  s_mul_i32 s48, s48, 3072
  s_add_u32 s42, s42, 1
  s_and_b32 s42, s42, 63
  s_waitcnt vmcnt(0)
  buffer_load_dwordx4 v[76:79], v2, s[8:11], s48 offen offset:0 nt
  buffer_load_dwordx4 v[80:83], v2, s[8:11], s48 offen offset:128 nt
  buffer_load_dwordx4 v[84:87], v2, s[8:11], s48 offen offset:256 nt
  buffer_load_dwordx4 v[164:167], v5, s[16:19], s49 offen offset:768
  s_nop 0
  v_mfma_f32_16x16x32_bf16 v[22:25], v[14:17], v[64:67], v[22:25]
  v_mfma_f32_16x16x32_bf16 v[26:29], v[14:17], v[68:71], v[26:29]
  v_mfma_f32_16x16x32_bf16 v[30:33], v[14:17], v[72:75], v[30:33]
  ds_read_b128 v[38:41], v60 offset:20224
  ds_read_b128 v[42:45], v60 offset:20240
  v_and_b32 v18, v47, v6
  v_and_b32 v19, v47, v7
  v_and_b32 v20, v47, v8
  v_and_b32 v21, v47, v9
  s_lshr_b32 s46, s42, 1
  s_lshl_b32 s46, s46, 4
  s_and_b32 s47, s42, 1
  s_add_u32 s48, s46, s47
  s_add_u32 s48, s48, s43
  s_and_b32 s48, s48, 511
  s_mul_i32 s48, s48, 3072
  s_add_u32 s42, s42, 1
  s_and_b32 s42, s42, 63
  s_waitcnt vmcnt(1)
  buffer_load_dwordx4 v[88:91], v2, s[8:11], s48 offen offset:0 nt
  buffer_load_dwordx4 v[92:95], v2, s[8:11], s48 offen offset:128 nt
  buffer_load_dwordx4 v[96:99], v2, s[8:11], s48 offen offset:256 nt
  s_nop 0
  v_mfma_f32_16x16x32_bf16 v[22:25], v[18:21], v[76:79], v[22:25]
  v_mfma_f32_16x16x32_bf16 v[26:29], v[18:21], v[80:83], v[26:29]
  v_mfma_f32_16x16x32_bf16 v[30:33], v[18:21], v[84:87], v[30:33]
  v_and_b32 v14, v48, v6
  v_and_b32 v15, v48, v7
  v_and_b32 v16, v48, v8
  v_and_b32 v17, v48, v9
  s_lshr_b32 s46, s42, 1
  s_lshl_b32 s46, s46, 4
  s_and_b32 s47, s42, 1
  s_add_u32 s48, s46, s47
  s_add_u32 s48, s48, s43
  s_and_b32 s48, s48, 511
  s_mul_i32 s48, s48, 3072
  s_add_u32 s42, s42, 1
  s_and_b32 s42, s42, 63
  s_waitcnt vmcnt(0)
  buffer_load_dwordx4 v[100:103], v2, s[8:11], s48 offen offset:0 nt
  buffer_load_dwordx4 v[104:107], v2, s[8:11], s48 offen offset:128 nt
  buffer_load_dwordx4 v[108:111], v2, s[8:11], s48 offen offset:256 nt
  buffer_load_dwordx4 v[168:171], v5, s[16:19], s49 offen offset:1024
  s_nop 0
  v_mfma_f32_16x16x32_bf16 v[22:25], v[14:17], v[88:91], v[22:25]
  v_mfma_f32_16x16x32_bf16 v[26:29], v[14:17], v[92:95], v[26:29]
  v_mfma_f32_16x16x32_bf16 v[30:33], v[14:17], v[96:99], v[30:33]
  v_and_b32 v18, v49, v6
  v_and_b32 v19, v49, v7
  v_and_b32 v20, v49, v8
  v_and_b32 v21, v49, v9
  s_lshr_b32 s46, s42, 1
  s_lshl_b32 s46, s46, 4
  s_and_b32 s47, s42, 1
  s_add_u32 s48, s46, s47
  s_add_u32 s48, s48, s43
  s_and_b32 s48, s48, 511
  s_mul_i32 s48, s48, 3072
  s_add_u32 s42, s42, 1
  s_and_b32 s42, s42, 63
  s_waitcnt vmcnt(1)
  buffer_load_dwordx4 v[64:67], v2, s[8:11], s48 offen offset:0 nt
  buffer_load_dwordx4 v[68:71], v2, s[8:11], s48 offen offset:128 nt
  buffer_load_dwordx4 v[72:75], v2, s[8:11], s48 offen offset:256 nt
  s_nop 0
  v_mfma_f32_16x16x32_bf16 v[22:25], v[18:21], v[100:103], v[22:25]
  v_mfma_f32_16x16x32_bf16 v[26:29], v[18:21], v[104:107], v[26:29]
  v_mfma_f32_16x16x32_bf16 v[30:33], v[18:21], v[108:111], v[30:33]
  v_and_b32 v14, v50, v6
  v_and_b32 v15, v50, v7
  v_and_b32 v16, v50, v8
  v_and_b32 v17, v50, v9
  s_lshr_b32 s46, s42, 1
  s_lshl_b32 s46, s46, 4
  s_and_b32 s47, s42, 1
  s_add_u32 s48, s46, s47
  s_add_u32 s48, s48, s43
  s_and_b32 s48, s48, 511
  s_mul_i32 s48, s48, 3072
  s_add_u32 s42, s42, 1
  s_and_b32 s42, s42, 63
  s_waitcnt vmcnt(0)
  buffer_load_dwordx4 v[76:79], v2, s[8:11], s48 offen offset:0 nt
  buffer_load_dwordx4 v[80:83], v2, s[8:11], s48 offen offset:128 nt
  buffer_load_dwordx4 v[84:87], v2, s[8:11], s48 offen offset:256 nt
  s_nop 0
  v_mfma_f32_16x16x32_bf16 v[22:25], v[14:17], v[64:67], v[22:25]
  v_mfma_f32_16x16x32_bf16 v[26:29], v[14:17], v[68:71], v[26:29]
  v_mfma_f32_16x16x32_bf16 v[30:33], v[14:17], v[72:75], v[30:33]
  v_and_b32 v18, v51, v6
  v_and_b32 v19, v51, v7
  v_and_b32 v20, v51, v8
  v_and_b32 v21, v51, v9
  s_lshr_b32 s46, s42, 1
  s_lshl_b32 s46, s46, 4
  s_and_b32 s47, s42, 1
  s_add_u32 s48, s46, s47
  s_add_u32 s48, s48, s43
  s_and_b32 s48, s48, 511
  s_mul_i32 s48, s48, 3072
  s_add_u32 s42, s42, 1
  s_and_b32 s42, s42, 63
  s_waitcnt vmcnt(0)
  buffer_load_dwordx4 v[88:91], v2, s[8:11], s48 offen offset:0 nt
  buffer_load_dwordx4 v[92:95], v2, s[8:11], s48 offen offset:128 nt
  buffer_load_dwordx4 v[96:99], v2, s[8:11], s48 offen offset:256 nt
  s_add_u32 s49, s49, 5120
  buffer_load_dwordx4 v[172:175], v5, s[16:19], s49 offen offset:0
  s_nop 0
  v_mfma_f32_16x16x32_bf16 v[22:25], v[18:21], v[76:79], v[22:25]
  v_mfma_f32_16x16x32_bf16 v[26:29], v[18:21], v[80:83], v[26:29]
  v_mfma_f32_16x16x32_bf16 v[30:33], v[18:21], v[84:87], v[30:33]
  v_and_b32 v14, v52, v6
  v_and_b32 v15, v52, v7
  v_and_b32 v16, v52, v8
  v_and_b32 v17, v52, v9
  s_lshr_b32 s46, s42, 1
  s_lshl_b32 s46, s46, 4
  s_and_b32 s47, s42, 1
  s_add_u32 s48, s46, s47
  s_add_u32 s48, s48, s43
  s_and_b32 s48, s48, 511
  s_mul_i32 s48, s48, 3072
  s_add_u32 s42, s42, 1
  s_and_b32 s42, s42, 63
  s_waitcnt vmcnt(1)
  buffer_load_dwordx4 v[100:103], v2, s[8:11], s48 offen offset:0 nt
  buffer_load_dwordx4 v[104:107], v2, s[8:11], s48 offen offset:128 nt
  buffer_load_dwordx4 v[108:111], v2, s[8:11], s48 offen offset:256 nt
  s_nop 0
  v_mfma_f32_16x16x32_bf16 v[22:25], v[14:17], v[88:91], v[22:25]
  v_mfma_f32_16x16x32_bf16 v[26:29], v[14:17], v[92:95], v[26:29]
  v_mfma_f32_16x16x32_bf16 v[30:33], v[14:17], v[96:99], v[30:33]
  v_and_b32 v18, v53, v6
  v_and_b32 v19, v53, v7
  v_and_b32 v20, v53, v8
  v_and_b32 v21, v53, v9
  s_lshr_b32 s46, s42, 1
  s_lshl_b32 s46, s46, 4
  s_and_b32 s47, s42, 1
  s_add_u32 s48, s46, s47
  s_add_u32 s48, s48, s43
  s_and_b32 s48, s48, 511
  s_mul_i32 s48, s48, 3072
  s_add_u32 s42, s42, 1
  s_and_b32 s42, s42, 63
  s_waitcnt vmcnt(0)
  buffer_load_dwordx4 v[64:67], v2, s[8:11], s48 offen offset:0 nt
  buffer_load_dwordx4 v[68:71], v2, s[8:11], s48 offen offset:128 nt
  buffer_load_dwordx4 v[72:75], v2, s[8:11], s48 offen offset:256 nt
  buffer_load_dwordx4 v[176:179], v5, s[16:19], s49 offen offset:256
  s_nop 0
  v_mfma_f32_16x16x32_bf16 v[22:25], v[18:21], v[100:103], v[22:25]
  v_mfma_f32_16x16x32_bf16 v[26:29], v[18:21], v[104:107], v[26:29]
  v_mfma_f32_16x16x32_bf16 v[30:33], v[18:21], v[108:111], v[30:33]
  s_waitcnt lgkmcnt(0)
  v_and_b32 v14, v38, v6
  v_and_b32 v15, v38, v7
  v_and_b32 v16, v38, v8
  v_and_b32 v17, v38, v9
  s_lshr_b32 s46, s42, 1
  s_lshl_b32 s46, s46, 4
  s_and_b32 s47, s42, 1
  s_add_u32 s48, s46, s47
  s_add_u32 s48, s48, s43
  s_and_b32 s48, s48, 511
  s_mul_i32 s48, s48, 3072
  s_add_u32 s42, s42, 1
  s_and_b32 s42, s42, 63
  s_waitcnt vmcnt(1)
  buffer_load_dwordx4 v[76:79], v2, s[8:11], s48 offen offset:0 nt
  buffer_load_dwordx4 v[80:83], v2, s[8:11], s48 offen offset:128 nt
  buffer_load_dwordx4 v[84:87], v2, s[8:11], s48 offen offset:256 nt
  s_nop 0
  v_mfma_f32_16x16x32_bf16 v[22:25], v[14:17], v[64:67], v[22:25]
  v_mfma_f32_16x16x32_bf16 v[26:29], v[14:17], v[68:71], v[26:29]
  v_mfma_f32_16x16x32_bf16 v[30:33], v[14:17], v[72:75], v[30:33]
  ds_read_b128 v[46:49], v60 offset:20480
  ds_read_b128 v[50:53], v60 offset:20496
  v_and_b32 v18, v39, v6
  v_and_b32 v19, v39, v7
  v_and_b32 v20, v39, v8
  v_and_b32 v21, v39, v9
  s_lshr_b32 s46, s42, 1
  s_lshl_b32 s46, s46, 4
  s_and_b32 s47, s42, 1
  s_add_u32 s48, s46, s47
  s_add_u32 s48, s48, s43
  s_and_b32 s48, s48, 511
  s_mul_i32 s48, s48, 3072
  s_add_u32 s42, s42, 1
  s_and_b32 s42, s42, 63
  s_waitcnt vmcnt(0)
  buffer_load_dwordx4 v[88:91], v2, s[8:11], s48 offen offset:0 nt
  buffer_load_dwordx4 v[92:95], v2, s[8:11], s48 offen offset:128 nt
  buffer_load_dwordx4 v[96:99], v2, s[8:11], s48 offen offset:256 nt
  buffer_load_dwordx4 v[180:183], v5, s[16:19], s49 offen offset:512
  s_nop 0
  v_mfma_f32_16x16x32_bf16 v[22:25], v[18:21], v[76:79], v[22:25]
  v_mfma_f32_16x16x32_bf16 v[26:29], v[18:21], v[80:83], v[26:29]
  v_mfma_f32_16x16x32_bf16 v[30:33], v[18:21], v[84:87], v[30:33]
  v_and_b32 v14, v40, v6
  v_and_b32 v15, v40, v7
  v_and_b32 v16, v40, v8
  v_and_b32 v17, v40, v9
  s_lshr_b32 s46, s42, 1
  s_lshl_b32 s46, s46, 4
  s_and_b32 s47, s42, 1
  s_add_u32 s48, s46, s47
  s_add_u32 s48, s48, s43
  s_and_b32 s48, s48, 511
  s_mul_i32 s48, s48, 3072
  s_add_u32 s42, s42, 1
  s_and_b32 s42, s42, 63
  s_waitcnt vmcnt(1)
  buffer_load_dwordx4 v[100:103], v2, s[8:11], s48 offen offset:0 nt
  buffer_load_dwordx4 v[104:107], v2, s[8:11], s48 offen offset:128 nt
  buffer_load_dwordx4 v[108:111], v2, s[8:11], s48 offen offset:256 nt
  s_nop 0
  v_mfma_f32_16x16x32_bf16 v[22:25], v[14:17], v[88:91], v[22:25]
  v_mfma_f32_16x16x32_bf16 v[26:29], v[14:17], v[92:95], v[26:29]
  v_mfma_f32_16x16x32_bf16 v[30:33], v[14:17], v[96:99], v[30:33]
  v_and_b32 v18, v41, v6
  v_and_b32 v19, v41, v7
  v_and_b32 v20, v41, v8
  v_and_b32 v21, v41, v9
  s_lshr_b32 s46, s42, 1
  s_lshl_b32 s46, s46, 4
  s_and_b32 s47, s42, 1
  s_add_u32 s48, s46, s47
  s_add_u32 s48, s48, s43
  s_and_b32 s48, s48, 511
  s_mul_i32 s48, s48, 3072
  s_add_u32 s42, s42, 1
  s_and_b32 s42, s42, 63
  s_waitcnt vmcnt(0)
  buffer_load_dwordx4 v[64:67], v2, s[8:11], s48 offen offset:0 nt
  buffer_load_dwordx4 v[68:71], v2, s[8:11], s48 offen offset:128 nt
  buffer_load_dwordx4 v[72:75], v2, s[8:11], s48 offen offset:256 nt
  buffer_load_dwordx4 v[184:187], v5, s[16:19], s49 offen offset:768
  s_nop 0
  v_mfma_f32_16x16x32_bf16 v[22:25], v[18:21], v[100:103], v[22:25]
  v_mfma_f32_16x16x32_bf16 v[26:29], v[18:21], v[104:107], v[26:29]
  v_mfma_f32_16x16x32_bf16 v[30:33], v[18:21], v[108:111], v[30:33]
  v_and_b32 v14, v42, v6
  v_and_b32 v15, v42, v7
  v_and_b32 v16, v42, v8
  v_and_b32 v17, v42, v9
  s_lshr_b32 s46, s42, 1
  s_lshl_b32 s46, s46, 4
  s_and_b32 s47, s42, 1
  s_add_u32 s48, s46, s47
  s_add_u32 s48, s48, s43
  s_and_b32 s48, s48, 511
  s_mul_i32 s48, s48, 3072
  s_add_u32 s42, s42, 1
  s_and_b32 s42, s42, 63
  s_waitcnt vmcnt(1)
  buffer_load_dwordx4 v[76:79], v2, s[8:11], s48 offen offset:0 nt
  buffer_load_dwordx4 v[80:83], v2, s[8:11], s48 offen offset:128 nt
  buffer_load_dwordx4 v[84:87], v2, s[8:11], s48 offen offset:256 nt
  s_nop 0
  v_mfma_f32_16x16x32_bf16 v[22:25], v[14:17], v[64:67], v[22:25]
  v_mfma_f32_16x16x32_bf16 v[26:29], v[14:17], v[68:71], v[26:29]
  v_mfma_f32_16x16x32_bf16 v[30:33], v[14:17], v[72:75], v[30:33]
  v_and_b32 v18, v43, v6
  v_and_b32 v19, v43, v7
  v_and_b32 v20, v43, v8
  v_and_b32 v21, v43, v9
  s_lshr_b32 s46, s42, 1
  s_lshl_b32 s46, s46, 4
  s_and_b32 s47, s42, 1
  s_add_u32 s48, s46, s47
  s_add_u32 s48, s48, s43
  s_and_b32 s48, s48, 511
  s_mul_i32 s48, s48, 3072
  s_add_u32 s42, s42, 1
  s_and_b32 s42, s42, 63
  s_waitcnt vmcnt(0)
  buffer_load_dwordx4 v[88:91], v2, s[8:11], s48 offen offset:0 nt
  buffer_load_dwordx4 v[92:95], v2, s[8:11], s48 offen offset:128 nt
  buffer_load_dwordx4 v[96:99], v2, s[8:11], s48 offen offset:256 nt
  buffer_load_dwordx4 v[188:191], v5, s[16:19], s49 offen offset:1024
  s_nop 0
  v_mfma_f32_16x16x32_bf16 v[22:25], v[18:21], v[76:79], v[22:25]
  v_mfma_f32_16x16x32_bf16 v[26:29], v[18:21], v[80:83], v[26:29]
  v_mfma_f32_16x16x32_bf16 v[30:33], v[18:21], v[84:87], v[30:33]
  v_and_b32 v14, v44, v6
  v_and_b32 v15, v44, v7
  v_and_b32 v16, v44, v8
  v_and_b32 v17, v44, v9
  s_lshr_b32 s46, s42, 1
  s_lshl_b32 s46, s46, 4
  s_and_b32 s47, s42, 1
  s_add_u32 s48, s46, s47
  s_add_u32 s48, s48, s43
  s_and_b32 s48, s48, 511
  s_mul_i32 s48, s48, 3072
  s_add_u32 s42, s42, 1
  s_and_b32 s42, s42, 63
  s_waitcnt vmcnt(1)
  buffer_load_dwordx4 v[100:103], v2, s[8:11], s48 offen offset:0 nt
  buffer_load_dwordx4 v[104:107], v2, s[8:11], s48 offen offset:128 nt
  buffer_load_dwordx4 v[108:111], v2, s[8:11], s48 offen offset:256 nt
  s_nop 0
  v_mfma_f32_16x16x32_bf16 v[22:25], v[14:17], v[88:91], v[22:25]
  v_mfma_f32_16x16x32_bf16 v[26:29], v[14:17], v[92:95], v[26:29]
  v_mfma_f32_16x16x32_bf16 v[30:33], v[14:17], v[96:99], v[30:33]
  v_and_b32 v18, v45, v6
  v_and_b32 v19, v45, v7
  v_and_b32 v20, v45, v8
  v_and_b32 v21, v45, v9
  s_lshr_b32 s46, s42, 1
  s_lshl_b32 s46, s46, 4
  s_and_b32 s47, s42, 1
  s_add_u32 s48, s46, s47
  s_add_u32 s48, s48, s43
  s_and_b32 s48, s48, 511
  s_mul_i32 s48, s48, 3072
  s_add_u32 s42, s42, 1
  s_and_b32 s42, s42, 63
  s_waitcnt vmcnt(0)
  buffer_load_dwordx4 v[64:67], v2, s[8:11], s48 offen offset:0 nt
  buffer_load_dwordx4 v[68:71], v2, s[8:11], s48 offen offset:128 nt
  buffer_load_dwordx4 v[72:75], v2, s[8:11], s48 offen offset:256 nt
  s_add_u32 s49, s49, 5120
  buffer_load_dwordx4 v[192:195], v5, s[16:19], s49 offen offset:0
  s_nop 0
  v_mfma_f32_16x16x32_bf16 v[22:25], v[18:21], v[100:103], v[22:25]
  v_mfma_f32_16x16x32_bf16 v[26:29], v[18:21], v[104:107], v[26:29]
  v_mfma_f32_16x16x32_bf16 v[30:33], v[18:21], v[108:111], v[30:33]
  s_waitcnt lgkmcnt(0)
  v_and_b32 v14, v46, v6
  v_and_b32 v15, v46, v7
  v_and_b32 v16, v46, v8
  v_and_b32 v17, v46, v9
  s_lshr_b32 s46, s42, 1
  s_lshl_b32 s46, s46, 4
  s_and_b32 s47, s42, 1
  s_add_u32 s48, s46, s47
  s_add_u32 s48, s48, s43
  s_and_b32 s48, s48, 511
  s_mul_i32 s48, s48, 3072
  s_add_u32 s42, s42, 1
  s_and_b32 s42, s42, 63
  s_waitcnt vmcnt(1)
  buffer_load_dwordx4 v[76:79], v2, s[8:11], s48 offen offset:0 nt
  buffer_load_dwordx4 v[80:83], v2, s[8:11], s48 offen offset:128 nt
  buffer_load_dwordx4 v[84:87], v2, s[8:11], s48 offen offset:256 nt
  s_nop 0
  v_mfma_f32_16x16x32_bf16 v[22:25], v[14:17], v[64:67], v[22:25]
  v_mfma_f32_16x16x32_bf16 v[26:29], v[14:17], v[68:71], v[26:29]
  v_mfma_f32_16x16x32_bf16 v[30:33], v[14:17], v[72:75], v[30:33]
  ds_read_b128 v[38:41], v60 offset:20736
  ds_read_b128 v[42:45], v60 offset:20752
  v_and_b32 v18, v47, v6
  v_and_b32 v19, v47, v7
  v_and_b32 v20, v47, v8
  v_and_b32 v21, v47, v9
  s_lshr_b32 s46, s42, 1
  s_lshl_b32 s46, s46, 4
  s_and_b32 s47, s42, 1
  s_add_u32 s48, s46, s47
  s_add_u32 s48, s48, s43
  s_and_b32 s48, s48, 511
  s_mul_i32 s48, s48, 3072
  s_add_u32 s42, s42, 1
  s_and_b32 s42, s42, 63
  s_waitcnt vmcnt(0)
  buffer_load_dwordx4 v[88:91], v2, s[8:11], s48 offen offset:0 nt
  buffer_load_dwordx4 v[92:95], v2, s[8:11], s48 offen offset:128 nt
  buffer_load_dwordx4 v[96:99], v2, s[8:11], s48 offen offset:256 nt
  buffer_load_dwordx4 v[196:199], v5, s[16:19], s49 offen offset:256
  s_nop 0
  v_mfma_f32_16x16x32_bf16 v[22:25], v[18:21], v[76:79], v[22:25]
  v_mfma_f32_16x16x32_bf16 v[26:29], v[18:21], v[80:83], v[26:29]
  v_mfma_f32_16x16x32_bf16 v[30:33], v[18:21], v[84:87], v[30:33]
  v_and_b32 v14, v48, v6
  v_and_b32 v15, v48, v7
  v_and_b32 v16, v48, v8
  v_and_b32 v17, v48, v9
  s_lshr_b32 s46, s42, 1
  s_lshl_b32 s46, s46, 4
  s_and_b32 s47, s42, 1
  s_add_u32 s48, s46, s47
  s_add_u32 s48, s48, s43
  s_and_b32 s48, s48, 511
  s_mul_i32 s48, s48, 3072
  s_add_u32 s42, s42, 1
  s_and_b32 s42, s42, 63
  s_waitcnt vmcnt(1)
  buffer_load_dwordx4 v[100:103], v2, s[8:11], s48 offen offset:0 nt
  buffer_load_dwordx4 v[104:107], v2, s[8:11], s48 offen offset:128 nt
  buffer_load_dwordx4 v[108:111], v2, s[8:11], s48 offen offset:256 nt
  s_nop 0
  v_mfma_f32_16x16x32_bf16 v[22:25], v[14:17], v[88:91], v[22:25]
  v_mfma_f32_16x16x32_bf16 v[26:29], v[14:17], v[92:95], v[26:29]
  v_mfma_f32_16x16x32_bf16 v[30:33], v[14:17], v[96:99], v[30:33]
  v_and_b32 v18, v49, v6
  v_and_b32 v19, v49, v7
  v_and_b32 v20, v49, v8
  v_and_b32 v21, v49, v9
  s_lshr_b32 s46, s42, 1
  s_lshl_b32 s46, s46, 4
  s_and_b32 s47, s42, 1
  s_add_u32 s48, s46, s47
  s_add_u32 s48, s48, s43
  s_and_b32 s48, s48, 511
  s_mul_i32 s48, s48, 3072
  s_add_u32 s42, s42, 1
  s_and_b32 s42, s42, 63
  s_waitcnt vmcnt(0)
  buffer_load_dwordx4 v[64:67], v2, s[8:11], s48 offen offset:0 nt
  buffer_load_dwordx4 v[68:71], v2, s[8:11], s48 offen offset:128 nt
  buffer_load_dwordx4 v[72:75], v2, s[8:11], s48 offen offset:256 nt
  buffer_load_dwordx4 v[200:203], v5, s[16:19], s49 offen offset:512
  s_nop 0
  v_mfma_f32_16x16x32_bf16 v[22:25], v[18:21], v[100:103], v[22:25]
  v_mfma_f32_16x16x32_bf16 v[26:29], v[18:21], v[104:107], v[26:29]
  v_mfma_f32_16x16x32_bf16 v[30:33], v[18:21], v[108:111], v[30:33]
  v_and_b32 v14, v50, v6
  v_and_b32 v15, v50, v7
  v_and_b32 v16, v50, v8
  v_and_b32 v17, v50, v9
  s_lshr_b32 s46, s42, 1
  s_lshl_b32 s46, s46, 4
  s_and_b32 s47, s42, 1
  s_add_u32 s48, s46, s47
  s_add_u32 s48, s48, s43
  s_and_b32 s48, s48, 511
  s_mul_i32 s48, s48, 3072
  s_add_u32 s42, s42, 1
  s_and_b32 s42, s42, 63
  s_waitcnt vmcnt(1)
  buffer_load_dwordx4 v[76:79], v2, s[8:11], s48 offen offset:0 nt
  buffer_load_dwordx4 v[80:83], v2, s[8:11], s48 offen offset:128 nt
  buffer_load_dwordx4 v[84:87], v2, s[8:11], s48 offen offset:256 nt
  s_nop 0
  v_mfma_f32_16x16x32_bf16 v[22:25], v[14:17], v[64:67], v[22:25]
  v_mfma_f32_16x16x32_bf16 v[26:29], v[14:17], v[68:71], v[26:29]
  v_mfma_f32_16x16x32_bf16 v[30:33], v[14:17], v[72:75], v[30:33]
  v_and_b32 v18, v51, v6
  v_and_b32 v19, v51, v7
  v_and_b32 v20, v51, v8
  v_and_b32 v21, v51, v9
  s_lshr_b32 s46, s42, 1
  s_lshl_b32 s46, s46, 4
  s_and_b32 s47, s42, 1
  s_add_u32 s48, s46, s47
  s_add_u32 s48, s48, s43
  s_and_b32 s48, s48, 511
  s_mul_i32 s48, s48, 3072
  s_add_u32 s42, s42, 1
  s_and_b32 s42, s42, 63
  s_waitcnt vmcnt(0)
  buffer_load_dwordx4 v[88:91], v2, s[8:11], s48 offen offset:0 nt
  buffer_load_dwordx4 v[92:95], v2, s[8:11], s48 offen offset:128 nt
  buffer_load_dwordx4 v[96:99], v2, s[8:11], s48 offen offset:256 nt
  buffer_load_dwordx4 v[204:207], v5, s[16:19], s49 offen offset:768
  s_nop 0
  v_mfma_f32_16x16x32_bf16 v[22:25], v[18:21], v[76:79], v[22:25]
  v_mfma_f32_16x16x32_bf16 v[26:29], v[18:21], v[80:83], v[26:29]
  v_mfma_f32_16x16x32_bf16 v[30:33], v[18:21], v[84:87], v[30:33]
  v_and_b32 v14, v52, v6
  v_and_b32 v15, v52, v7
  v_and_b32 v16, v52, v8
  v_and_b32 v17, v52, v9
  s_lshr_b32 s46, s42, 1
  s_lshl_b32 s46, s46, 4
  s_and_b32 s47, s42, 1
  s_add_u32 s48, s46, s47
  s_add_u32 s48, s48, s43
  s_and_b32 s48, s48, 511
  s_mul_i32 s48, s48, 3072
  s_add_u32 s42, s42, 1
  s_and_b32 s42, s42, 63
  s_waitcnt vmcnt(1)
  buffer_load_dwordx4 v[100:103], v2, s[8:11], s48 offen offset:0 nt
  buffer_load_dwordx4 v[104:107], v2, s[8:11], s48 offen offset:128 nt
  buffer_load_dwordx4 v[108:111], v2, s[8:11], s48 offen offset:256 nt
  s_nop 0
  v_mfma_f32_16x16x32_bf16 v[22:25], v[14:17], v[88:91], v[22:25]
  v_mfma_f32_16x16x32_bf16 v[26:29], v[14:17], v[92:95], v[26:29]
  v_mfma_f32_16x16x32_bf16 v[30:33], v[14:17], v[96:99], v[30:33]
  v_and_b32 v18, v53, v6
  v_and_b32 v19, v53, v7
  v_and_b32 v20, v53, v8
  v_and_b32 v21, v53, v9
  s_lshr_b32 s46, s42, 1
  s_lshl_b32 s46, s46, 4
  s_and_b32 s47, s42, 1
  s_add_u32 s48, s46, s47
  s_add_u32 s48, s48, s43
  s_and_b32 s48, s48, 511
  s_mul_i32 s48, s48, 3072
  s_add_u32 s42, s42, 1
  s_and_b32 s42, s42, 63
  s_waitcnt vmcnt(0)
  buffer_load_dwordx4 v[64:67], v2, s[8:11], s48 offen offset:0 nt
  buffer_load_dwordx4 v[68:71], v2, s[8:11], s48 offen offset:128 nt
  buffer_load_dwordx4 v[72:75], v2, s[8:11], s48 offen offset:256 nt
  buffer_load_dwordx4 v[208:211], v5, s[16:19], s49 offen offset:1024
  s_nop 0
  v_mfma_f32_16x16x32_bf16 v[22:25], v[18:21], v[100:103], v[22:25]
  v_mfma_f32_16x16x32_bf16 v[26:29], v[18:21], v[104:107], v[26:29]
  v_mfma_f32_16x16x32_bf16 v[30:33], v[18:21], v[108:111], v[30:33]
  s_waitcnt lgkmcnt(0)
  v_and_b32 v14, v38, v6
  v_and_b32 v15, v38, v7
  v_and_b32 v16, v38, v8
  v_and_b32 v17, v38, v9
  s_lshr_b32 s46, s42, 1
  s_lshl_b32 s46, s46, 4
  s_and_b32 s47, s42, 1
  s_add_u32 s48, s46, s47
  s_add_u32 s48, s48, s43
  s_and_b32 s48, s48, 511
  s_mul_i32 s48, s48, 3072
  s_add_u32 s42, s42, 1
  s_and_b32 s42, s42, 63
  s_waitcnt vmcnt(1)
  buffer_load_dwordx4 v[76:79], v2, s[8:11], s48 offen offset:0 nt
  buffer_load_dwordx4 v[80:83], v2, s[8:11], s48 offen offset:128 nt
  buffer_load_dwordx4 v[84:87], v2, s[8:11], s48 offen offset:256 nt
  s_nop 0
  v_mfma_f32_16x16x32_bf16 v[22:25], v[14:17], v[64:67], v[22:25]
  v_mfma_f32_16x16x32_bf16 v[26:29], v[14:17], v[68:71], v[26:29]
  v_mfma_f32_16x16x32_bf16 v[30:33], v[14:17], v[72:75], v[30:33]
  ds_read_b128 v[46:49], v60 offset:20992
  ds_read_b128 v[50:53], v60 offset:21008
  v_and_b32 v18, v39, v6
  v_and_b32 v19, v39, v7
  v_and_b32 v20, v39, v8
  v_and_b32 v21, v39, v9
  s_lshr_b32 s46, s42, 1
  s_lshl_b32 s46, s46, 4
  s_and_b32 s47, s42, 1
  s_add_u32 s48, s46, s47
  s_add_u32 s48, s48, s43
  s_and_b32 s48, s48, 511
  s_mul_i32 s48, s48, 3072
  s_add_u32 s42, s42, 1
  s_and_b32 s42, s42, 63
  s_waitcnt vmcnt(0)
  buffer_load_dwordx4 v[88:91], v2, s[8:11], s48 offen offset:0 nt
  buffer_load_dwordx4 v[92:95], v2, s[8:11], s48 offen offset:128 nt
  buffer_load_dwordx4 v[96:99], v2, s[8:11], s48 offen offset:256 nt
  s_add_u32 s49, s49, 5120
  buffer_load_dwordx4 v[212:215], v5, s[16:19], s49 offen offset:0
  s_nop 0
  v_mfma_f32_16x16x32_bf16 v[22:25], v[18:21], v[76:79], v[22:25]
  v_mfma_f32_16x16x32_bf16 v[26:29], v[18:21], v[80:83], v[26:29]
  v_mfma_f32_16x16x32_bf16 v[30:33], v[18:21], v[84:87], v[30:33]
  v_and_b32 v14, v40, v6
  v_and_b32 v15, v40, v7
  v_and_b32 v16, v40, v8
  v_and_b32 v17, v40, v9
  s_lshr_b32 s46, s42, 1
  s_lshl_b32 s46, s46, 4
  s_and_b32 s47, s42, 1
  s_add_u32 s48, s46, s47
  s_add_u32 s48, s48, s43
  s_and_b32 s48, s48, 511
  s_mul_i32 s48, s48, 3072
  s_add_u32 s42, s42, 1
  s_and_b32 s42, s42, 63
  s_waitcnt vmcnt(1)
  buffer_load_dwordx4 v[100:103], v2, s[8:11], s48 offen offset:0 nt
  buffer_load_dwordx4 v[104:107], v2, s[8:11], s48 offen offset:128 nt
  buffer_load_dwordx4 v[108:111], v2, s[8:11], s48 offen offset:256 nt
  s_nop 0
  v_mfma_f32_16x16x32_bf16 v[22:25], v[14:17], v[88:91], v[22:25]
  v_mfma_f32_16x16x32_bf16 v[26:29], v[14:17], v[92:95], v[26:29]
  v_mfma_f32_16x16x32_bf16 v[30:33], v[14:17], v[96:99], v[30:33]
  v_and_b32 v18, v41, v6
  v_and_b32 v19, v41, v7
  v_and_b32 v20, v41, v8
  v_and_b32 v21, v41, v9
  s_lshr_b32 s46, s42, 1
  s_lshl_b32 s46, s46, 4
  s_and_b32 s47, s42, 1
  s_add_u32 s48, s46, s47
  s_add_u32 s48, s48, s43
  s_and_b32 s48, s48, 511
  s_mul_i32 s48, s48, 3072
  s_add_u32 s42, s42, 1
  s_and_b32 s42, s42, 63
  s_waitcnt vmcnt(0)
  buffer_load_dwordx4 v[64:67], v2, s[8:11], s48 offen offset:0 nt
  buffer_load_dwordx4 v[68:71], v2, s[8:11], s48 offen offset:128 nt
  buffer_load_dwordx4 v[72:75], v2, s[8:11], s48 offen offset:256 nt
  buffer_load_dwordx4 v[216:219], v5, s[16:19], s49 offen offset:256
  s_nop 0
  v_mfma_f32_16x16x32_bf16 v[22:25], v[18:21], v[100:103], v[22:25]
  v_mfma_f32_16x16x32_bf16 v[26:29], v[18:21], v[104:107], v[26:29]
  v_mfma_f32_16x16x32_bf16 v[30:33], v[18:21], v[108:111], v[30:33]
  v_and_b32 v14, v42, v6
  v_and_b32 v15, v42, v7
  v_and_b32 v16, v42, v8
  v_and_b32 v17, v42, v9
  s_lshr_b32 s46, s42, 1
  s_lshl_b32 s46, s46, 4
  s_and_b32 s47, s42, 1
  s_add_u32 s48, s46, s47
  s_add_u32 s48, s48, s43
  s_and_b32 s48, s48, 511
  s_mul_i32 s48, s48, 3072
  s_add_u32 s42, s42, 1
  s_and_b32 s42, s42, 63
  s_waitcnt vmcnt(1)
  buffer_load_dwordx4 v[76:79], v2, s[8:11], s48 offen offset:0 nt
  buffer_load_dwordx4 v[80:83], v2, s[8:11], s48 offen offset:128 nt
  buffer_load_dwordx4 v[84:87], v2, s[8:11], s48 offen offset:256 nt
  s_nop 0
  v_mfma_f32_16x16x32_bf16 v[22:25], v[14:17], v[64:67], v[22:25]
  v_mfma_f32_16x16x32_bf16 v[26:29], v[14:17], v[68:71], v[26:29]
  v_mfma_f32_16x16x32_bf16 v[30:33], v[14:17], v[72:75], v[30:33]
  v_and_b32 v18, v43, v6
  v_and_b32 v19, v43, v7
  v_and_b32 v20, v43, v8
  v_and_b32 v21, v43, v9
  s_lshr_b32 s46, s42, 1
  s_lshl_b32 s46, s46, 4
  s_and_b32 s47, s42, 1
  s_add_u32 s48, s46, s47
  s_add_u32 s48, s48, s43
  s_and_b32 s48, s48, 511
  s_mul_i32 s48, s48, 3072
  s_add_u32 s42, s42, 1
  s_and_b32 s42, s42, 63
  s_waitcnt vmcnt(0)
  buffer_load_dwordx4 v[88:91], v2, s[8:11], s48 offen offset:0 nt
  buffer_load_dwordx4 v[92:95], v2, s[8:11], s48 offen offset:128 nt
  buffer_load_dwordx4 v[96:99], v2, s[8:11], s48 offen offset:256 nt
  buffer_load_dwordx4 v[220:223], v5, s[16:19], s49 offen offset:512
  s_nop 0
  v_mfma_f32_16x16x32_bf16 v[22:25], v[18:21], v[76:79], v[22:25]
  v_mfma_f32_16x16x32_bf16 v[26:29], v[18:21], v[80:83], v[26:29]
  v_mfma_f32_16x16x32_bf16 v[30:33], v[18:21], v[84:87], v[30:33]
  v_and_b32 v14, v44, v6
  v_and_b32 v15, v44, v7
  v_and_b32 v16, v44, v8
  v_and_b32 v17, v44, v9
  s_lshr_b32 s46, s42, 1
  s_lshl_b32 s46, s46, 4
  s_and_b32 s47, s42, 1
  s_add_u32 s48, s46, s47
  s_add_u32 s48, s48, s43
  s_and_b32 s48, s48, 511
  s_mul_i32 s48, s48, 3072
  s_add_u32 s42, s42, 1
  s_and_b32 s42, s42, 63
  s_waitcnt vmcnt(1)
  buffer_load_dwordx4 v[100:103], v2, s[8:11], s48 offen offset:0 nt
  buffer_load_dwordx4 v[104:107], v2, s[8:11], s48 offen offset:128 nt
  buffer_load_dwordx4 v[108:111], v2, s[8:11], s48 offen offset:256 nt
  s_nop 0
  v_mfma_f32_16x16x32_bf16 v[22:25], v[14:17], v[88:91], v[22:25]
  v_mfma_f32_16x16x32_bf16 v[26:29], v[14:17], v[92:95], v[26:29]
  v_mfma_f32_16x16x32_bf16 v[30:33], v[14:17], v[96:99], v[30:33]
  v_and_b32 v18, v45, v6
  v_and_b32 v19, v45, v7
  v_and_b32 v20, v45, v8
  v_and_b32 v21, v45, v9
  s_lshr_b32 s46, s42, 1
  s_lshl_b32 s46, s46, 4
  s_and_b32 s47, s42, 1
  s_add_u32 s48, s46, s47
  s_add_u32 s48, s48, s43
  s_and_b32 s48, s48, 511
  s_mul_i32 s48, s48, 3072
  s_add_u32 s42, s42, 1
  s_and_b32 s42, s42, 63
  s_waitcnt vmcnt(0)
  buffer_load_dwordx4 v[64:67], v2, s[8:11], s48 offen offset:0 nt
  buffer_load_dwordx4 v[68:71], v2, s[8:11], s48 offen offset:128 nt
  buffer_load_dwordx4 v[72:75], v2, s[8:11], s48 offen offset:256 nt
  buffer_load_dwordx4 v[224:227], v5, s[16:19], s49 offen offset:768
  s_nop 0
  v_mfma_f32_16x16x32_bf16 v[22:25], v[18:21], v[100:103], v[22:25]
  v_mfma_f32_16x16x32_bf16 v[26:29], v[18:21], v[104:107], v[26:29]
  v_mfma_f32_16x16x32_bf16 v[30:33], v[18:21], v[108:111], v[30:33]
  s_waitcnt lgkmcnt(0)
  v_and_b32 v14, v46, v6
  v_and_b32 v15, v46, v7
  v_and_b32 v16, v46, v8
  v_and_b32 v17, v46, v9
  s_lshr_b32 s46, s42, 1
  s_lshl_b32 s46, s46, 4
  s_and_b32 s47, s42, 1
  s_add_u32 s48, s46, s47
  s_add_u32 s48, s48, s43
  s_and_b32 s48, s48, 511
  s_mul_i32 s48, s48, 3072
  s_add_u32 s42, s42, 1
  s_and_b32 s42, s42, 63
  s_waitcnt vmcnt(1)
  buffer_load_dwordx4 v[76:79], v2, s[8:11], s48 offen offset:0 nt
  buffer_load_dwordx4 v[80:83], v2, s[8:11], s48 offen offset:128 nt
  buffer_load_dwordx4 v[84:87], v2, s[8:11], s48 offen offset:256 nt
  s_nop 0
  v_mfma_f32_16x16x32_bf16 v[22:25], v[14:17], v[64:67], v[22:25]
  v_mfma_f32_16x16x32_bf16 v[26:29], v[14:17], v[68:71], v[26:29]
  v_mfma_f32_16x16x32_bf16 v[30:33], v[14:17], v[72:75], v[30:33]
  ds_read_b128 v[38:41], v60 offset:21248
  ds_read_b128 v[42:45], v60 offset:21264
  v_and_b32 v18, v47, v6
  v_and_b32 v19, v47, v7
  v_and_b32 v20, v47, v8
  v_and_b32 v21, v47, v9
  s_lshr_b32 s46, s42, 1
  s_lshl_b32 s46, s46, 4
  s_and_b32 s47, s42, 1
  s_add_u32 s48, s46, s47
  s_add_u32 s48, s48, s43
  s_and_b32 s48, s48, 511
  s_mul_i32 s48, s48, 3072
  s_add_u32 s42, s42, 1
  s_and_b32 s42, s42, 63
  s_waitcnt vmcnt(0)
  buffer_load_dwordx4 v[88:91], v2, s[8:11], s48 offen offset:0 nt
  buffer_load_dwordx4 v[92:95], v2, s[8:11], s48 offen offset:128 nt
  buffer_load_dwordx4 v[96:99], v2, s[8:11], s48 offen offset:256 nt
  s_nop 0
  v_mfma_f32_16x16x32_bf16 v[22:25], v[18:21], v[76:79], v[22:25]
  v_mfma_f32_16x16x32_bf16 v[26:29], v[18:21], v[80:83], v[26:29]
  v_mfma_f32_16x16x32_bf16 v[30:33], v[18:21], v[84:87], v[30:33]
  v_and_b32 v14, v48, v6
  v_and_b32 v15, v48, v7
  v_and_b32 v16, v48, v8
  v_and_b32 v17, v48, v9
  s_lshr_b32 s46, s42, 1
  s_lshl_b32 s46, s46, 4
  s_and_b32 s47, s42, 1
  s_add_u32 s48, s46, s47
  s_add_u32 s48, s48, s43
  s_and_b32 s48, s48, 511
  s_mul_i32 s48, s48, 3072
  s_add_u32 s42, s42, 1
  s_and_b32 s42, s42, 63
  s_waitcnt vmcnt(0)
  buffer_load_dwordx4 v[100:103], v2, s[8:11], s48 offen offset:0 nt
  buffer_load_dwordx4 v[104:107], v2, s[8:11], s48 offen offset:128 nt
  buffer_load_dwordx4 v[108:111], v2, s[8:11], s48 offen offset:256 nt
  buffer_load_dwordx4 v[228:231], v5, s[16:19], s49 offen offset:1024
  s_nop 0
  v_mfma_f32_16x16x32_bf16 v[22:25], v[14:17], v[88:91], v[22:25]
  v_mfma_f32_16x16x32_bf16 v[26:29], v[14:17], v[92:95], v[26:29]
  v_mfma_f32_16x16x32_bf16 v[30:33], v[14:17], v[96:99], v[30:33]
  v_and_b32 v18, v49, v6
  v_and_b32 v19, v49, v7
  v_and_b32 v20, v49, v8
  v_and_b32 v21, v49, v9
  s_lshr_b32 s46, s42, 1
  s_lshl_b32 s46, s46, 4
  s_and_b32 s47, s42, 1
  s_add_u32 s48, s46, s47
  s_add_u32 s48, s48, s43
  s_and_b32 s48, s48, 511
  s_mul_i32 s48, s48, 3072
  s_add_u32 s42, s42, 1
  s_and_b32 s42, s42, 63
  s_waitcnt vmcnt(1)
  buffer_load_dwordx4 v[64:67], v2, s[8:11], s48 offen offset:0 nt
  buffer_load_dwordx4 v[68:71], v2, s[8:11], s48 offen offset:128 nt
  buffer_load_dwordx4 v[72:75], v2, s[8:11], s48 offen offset:256 nt
  s_nop 0
  v_mfma_f32_16x16x32_bf16 v[22:25], v[18:21], v[100:103], v[22:25]
  v_mfma_f32_16x16x32_bf16 v[26:29], v[18:21], v[104:107], v[26:29]
  v_mfma_f32_16x16x32_bf16 v[30:33], v[18:21], v[108:111], v[30:33]
  v_and_b32 v14, v50, v6
  v_and_b32 v15, v50, v7
  v_and_b32 v16, v50, v8
  v_and_b32 v17, v50, v9
  s_lshr_b32 s46, s42, 1
  s_lshl_b32 s46, s46, 4
  s_and_b32 s47, s42, 1
  s_add_u32 s48, s46, s47
  s_add_u32 s48, s48, s43
  s_and_b32 s48, s48, 511
  s_mul_i32 s48, s48, 3072
  s_add_u32 s42, s42, 1
  s_and_b32 s42, s42, 63
  s_waitcnt vmcnt(0)
  buffer_load_dwordx4 v[76:79], v2, s[8:11], s48 offen offset:0 nt
  buffer_load_dwordx4 v[80:83], v2, s[8:11], s48 offen offset:128 nt
  buffer_load_dwordx4 v[84:87], v2, s[8:11], s48 offen offset:256 nt
  s_nop 0
  v_mfma_f32_16x16x32_bf16 v[22:25], v[14:17], v[64:67], v[22:25]
  v_mfma_f32_16x16x32_bf16 v[26:29], v[14:17], v[68:71], v[26:29]
  v_mfma_f32_16x16x32_bf16 v[30:33], v[14:17], v[72:75], v[30:33]
  v_and_b32 v18, v51, v6
  v_and_b32 v19, v51, v7
  v_and_b32 v20, v51, v8
  v_and_b32 v21, v51, v9
  s_lshr_b32 s46, s42, 1
  s_lshl_b32 s46, s46, 4
  s_and_b32 s47, s42, 1
  s_add_u32 s48, s46, s47
  s_add_u32 s48, s48, s43
  s_and_b32 s48, s48, 511
  s_mul_i32 s48, s48, 3072
  s_add_u32 s42, s42, 1
  s_and_b32 s42, s42, 63
  s_waitcnt vmcnt(0)
  buffer_load_dwordx4 v[88:91], v2, s[8:11], s48 offen offset:0 nt
  buffer_load_dwordx4 v[92:95], v2, s[8:11], s48 offen offset:128 nt
  buffer_load_dwordx4 v[96:99], v2, s[8:11], s48 offen offset:256 nt
  s_nop 0
  v_mfma_f32_16x16x32_bf16 v[22:25], v[18:21], v[76:79], v[22:25]
  v_mfma_f32_16x16x32_bf16 v[26:29], v[18:21], v[80:83], v[26:29]
  v_mfma_f32_16x16x32_bf16 v[30:33], v[18:21], v[84:87], v[30:33]
  v_and_b32 v14, v52, v6
  v_and_b32 v15, v52, v7
  v_and_b32 v16, v52, v8
  v_and_b32 v17, v52, v9
  s_lshr_b32 s46, s42, 1
  s_lshl_b32 s46, s46, 4
  s_and_b32 s47, s42, 1
  s_add_u32 s48, s46, s47
  s_add_u32 s48, s48, s43
  s_and_b32 s48, s48, 511
  s_mul_i32 s48, s48, 3072
  s_add_u32 s42, s42, 1
  s_and_b32 s42, s42, 63
  s_waitcnt vmcnt(0)
  buffer_load_dwordx4 v[100:103], v2, s[8:11], s48 offen offset:0 nt
  buffer_load_dwordx4 v[104:107], v2, s[8:11], s48 offen offset:128 nt
  buffer_load_dwordx4 v[108:111], v2, s[8:11], s48 offen offset:256 nt
  s_nop 0
  v_mfma_f32_16x16x32_bf16 v[22:25], v[14:17], v[88:91], v[22:25]
  v_mfma_f32_16x16x32_bf16 v[26:29], v[14:17], v[92:95], v[26:29]
  v_mfma_f32_16x16x32_bf16 v[30:33], v[14:17], v[96:99], v[30:33]
  v_and_b32 v18, v53, v6
  v_and_b32 v19, v53, v7
  v_and_b32 v20, v53, v8
  v_and_b32 v21, v53, v9
  s_lshr_b32 s46, s42, 1
  s_lshl_b32 s46, s46, 4
  s_and_b32 s47, s42, 1
  s_add_u32 s48, s46, s47
  s_add_u32 s48, s48, s43
  s_and_b32 s48, s48, 511
  s_mul_i32 s48, s48, 3072
  s_add_u32 s42, s42, 1
  s_and_b32 s42, s42, 63
  s_waitcnt vmcnt(0)
  buffer_load_dwordx4 v[64:67], v2, s[8:11], s48 offen offset:0 nt
  buffer_load_dwordx4 v[68:71], v2, s[8:11], s48 offen offset:128 nt
  buffer_load_dwordx4 v[72:75], v2, s[8:11], s48 offen offset:256 nt
  s_nop 0
  v_mfma_f32_16x16x32_bf16 v[22:25], v[18:21], v[100:103], v[22:25]
  v_mfma_f32_16x16x32_bf16 v[26:29], v[18:21], v[104:107], v[26:29]
  v_mfma_f32_16x16x32_bf16 v[30:33], v[18:21], v[108:111], v[30:33]
  s_waitcnt lgkmcnt(0)
  v_and_b32 v14, v38, v6
  v_and_b32 v15, v38, v7
  v_and_b32 v16, v38, v8
  v_and_b32 v17, v38, v9
  s_lshr_b32 s46, s42, 1
  s_lshl_b32 s46, s46, 4
  s_and_b32 s47, s42, 1
  s_add_u32 s48, s46, s47
  s_add_u32 s48, s48, s43
  s_and_b32 s48, s48, 511
  s_mul_i32 s48, s48, 3072
  s_add_u32 s42, s42, 1
  s_and_b32 s42, s42, 63
  s_waitcnt vmcnt(0)
  buffer_load_dwordx4 v[76:79], v2, s[8:11], s48 offen offset:0 nt
  buffer_load_dwordx4 v[80:83], v2, s[8:11], s48 offen offset:128 nt
  buffer_load_dwordx4 v[84:87], v2, s[8:11], s48 offen offset:256 nt
  s_nop 0
  v_mfma_f32_16x16x32_bf16 v[22:25], v[14:17], v[64:67], v[22:25]
  v_mfma_f32_16x16x32_bf16 v[26:29], v[14:17], v[68:71], v[26:29]
  v_mfma_f32_16x16x32_bf16 v[30:33], v[14:17], v[72:75], v[30:33]
  ds_read_b128 v[46:49], v60 offset:21504
  ds_read_b128 v[50:53], v60 offset:21520
  v_and_b32 v18, v39, v6
  v_and_b32 v19, v39, v7
  v_and_b32 v20, v39, v8
  v_and_b32 v21, v39, v9
  s_lshr_b32 s46, s42, 1
  s_lshl_b32 s46, s46, 4
  s_and_b32 s47, s42, 1
  s_add_u32 s48, s46, s47
  s_add_u32 s48, s48, s43
  s_and_b32 s48, s48, 511
  s_mul_i32 s48, s48, 3072
  s_add_u32 s42, s42, 1
  s_and_b32 s42, s42, 63
  s_waitcnt vmcnt(0)
  buffer_load_dwordx4 v[88:91], v2, s[8:11], s48 offen offset:0 nt
  buffer_load_dwordx4 v[92:95], v2, s[8:11], s48 offen offset:128 nt
  buffer_load_dwordx4 v[96:99], v2, s[8:11], s48 offen offset:256 nt
  s_nop 0
  v_mfma_f32_16x16x32_bf16 v[22:25], v[18:21], v[76:79], v[22:25]
  v_mfma_f32_16x16x32_bf16 v[26:29], v[18:21], v[80:83], v[26:29]
  v_mfma_f32_16x16x32_bf16 v[30:33], v[18:21], v[84:87], v[30:33]
  v_and_b32 v14, v40, v6
  v_and_b32 v15, v40, v7
  v_and_b32 v16, v40, v8
  v_and_b32 v17, v40, v9
  s_lshr_b32 s46, s42, 1
  s_lshl_b32 s46, s46, 4
  s_and_b32 s47, s42, 1
  s_add_u32 s48, s46, s47
  s_add_u32 s48, s48, s43
  s_and_b32 s48, s48, 511
  s_mul_i32 s48, s48, 3072
  s_add_u32 s42, s42, 1
  s_and_b32 s42, s42, 63
  s_waitcnt vmcnt(0)
  buffer_load_dwordx4 v[100:103], v2, s[8:11], s48 offen offset:0 nt
  buffer_load_dwordx4 v[104:107], v2, s[8:11], s48 offen offset:128 nt
  buffer_load_dwordx4 v[108:111], v2, s[8:11], s48 offen offset:256 nt
  s_nop 0
  v_mfma_f32_16x16x32_bf16 v[22:25], v[14:17], v[88:91], v[22:25]
  v_mfma_f32_16x16x32_bf16 v[26:29], v[14:17], v[92:95], v[26:29]
  v_mfma_f32_16x16x32_bf16 v[30:33], v[14:17], v[96:99], v[30:33]
  v_and_b32 v18, v41, v6
  v_and_b32 v19, v41, v7
  v_and_b32 v20, v41, v8
  v_and_b32 v21, v41, v9
  s_lshr_b32 s46, s42, 1
  s_lshl_b32 s46, s46, 4
  s_and_b32 s47, s42, 1
  s_add_u32 s48, s46, s47
  s_add_u32 s48, s48, s43
  s_and_b32 s48, s48, 511
  s_mul_i32 s48, s48, 3072
  s_add_u32 s42, s42, 1
  s_and_b32 s42, s42, 63
  s_waitcnt vmcnt(0)
  buffer_load_dwordx4 v[64:67], v2, s[8:11], s48 offen offset:0 nt
  buffer_load_dwordx4 v[68:71], v2, s[8:11], s48 offen offset:128 nt
  buffer_load_dwordx4 v[72:75], v2, s[8:11], s48 offen offset:256 nt
  s_nop 0
  v_mfma_f32_16x16x32_bf16 v[22:25], v[18:21], v[100:103], v[22:25]
  v_mfma_f32_16x16x32_bf16 v[26:29], v[18:21], v[104:107], v[26:29]
  v_mfma_f32_16x16x32_bf16 v[30:33], v[18:21], v[108:111], v[30:33]
  v_and_b32 v14, v42, v6
  v_and_b32 v15, v42, v7
  v_and_b32 v16, v42, v8
  v_and_b32 v17, v42, v9
  s_lshr_b32 s46, s42, 1
  s_lshl_b32 s46, s46, 4
  s_and_b32 s47, s42, 1
  s_add_u32 s48, s46, s47
  s_add_u32 s48, s48, s43
  s_and_b32 s48, s48, 511
  s_mul_i32 s48, s48, 3072
  s_add_u32 s42, s42, 1
  s_and_b32 s42, s42, 63
  s_waitcnt vmcnt(0)
  buffer_load_dwordx4 v[76:79], v2, s[8:11], s48 offen offset:0 nt
  buffer_load_dwordx4 v[80:83], v2, s[8:11], s48 offen offset:128 nt
  buffer_load_dwordx4 v[84:87], v2, s[8:11], s48 offen offset:256 nt
  s_nop 0
  v_mfma_f32_16x16x32_bf16 v[22:25], v[14:17], v[64:67], v[22:25]
  v_mfma_f32_16x16x32_bf16 v[26:29], v[14:17], v[68:71], v[26:29]
  v_mfma_f32_16x16x32_bf16 v[30:33], v[14:17], v[72:75], v[30:33]
  v_and_b32 v18, v43, v6
  v_and_b32 v19, v43, v7
  v_and_b32 v20, v43, v8
  v_and_b32 v21, v43, v9
  s_lshr_b32 s46, s42, 1
  s_lshl_b32 s46, s46, 4
  s_and_b32 s47, s42, 1
  s_add_u32 s48, s46, s47
  s_add_u32 s48, s48, s43
  s_and_b32 s48, s48, 511
  s_mul_i32 s48, s48, 3072
  s_add_u32 s42, s42, 1
  s_and_b32 s42, s42, 63
  s_waitcnt vmcnt(0)
  buffer_load_dwordx4 v[88:91], v2, s[8:11], s48 offen offset:0 nt
  buffer_load_dwordx4 v[92:95], v2, s[8:11], s48 offen offset:128 nt
  buffer_load_dwordx4 v[96:99], v2, s[8:11], s48 offen offset:256 nt
  s_nop 0
  v_mfma_f32_16x16x32_bf16 v[22:25], v[18:21], v[76:79], v[22:25]
  v_mfma_f32_16x16x32_bf16 v[26:29], v[18:21], v[80:83], v[26:29]
  v_mfma_f32_16x16x32_bf16 v[30:33], v[18:21], v[84:87], v[30:33]
  v_and_b32 v14, v44, v6
  v_and_b32 v15, v44, v7
  v_and_b32 v16, v44, v8
  v_and_b32 v17, v44, v9
  s_lshr_b32 s46, s42, 1
  s_lshl_b32 s46, s46, 4
  s_and_b32 s47, s42, 1
  s_add_u32 s48, s46, s47
  s_add_u32 s48, s48, s43
  s_and_b32 s48, s48, 511
  s_mul_i32 s48, s48, 3072
  s_add_u32 s42, s42, 1
  s_and_b32 s42, s42, 63
  s_waitcnt vmcnt(0)
  buffer_load_dwordx4 v[100:103], v2, s[8:11], s48 offen offset:0 nt
  buffer_load_dwordx4 v[104:107], v2, s[8:11], s48 offen offset:128 nt
  buffer_load_dwordx4 v[108:111], v2, s[8:11], s48 offen offset:256 nt
  s_nop 0
  v_mfma_f32_16x16x32_bf16 v[22:25], v[14:17], v[88:91], v[22:25]
  v_mfma_f32_16x16x32_bf16 v[26:29], v[14:17], v[92:95], v[26:29]
  v_mfma_f32_16x16x32_bf16 v[30:33], v[14:17], v[96:99], v[30:33]
  v_and_b32 v18, v45, v6
  v_and_b32 v19, v45, v7
  v_and_b32 v20, v45, v8
  v_and_b32 v21, v45, v9
  s_lshr_b32 s46, s42, 1
  s_lshl_b32 s46, s46, 4
  s_and_b32 s47, s42, 1
  s_add_u32 s48, s46, s47
  s_add_u32 s48, s48, s43
  s_and_b32 s48, s48, 511
  s_mul_i32 s48, s48, 3072
  s_add_u32 s42, s42, 1
  s_and_b32 s42, s42, 63
  s_waitcnt vmcnt(0)
  buffer_load_dwordx4 v[64:67], v2, s[8:11], s48 offen offset:0 nt
  buffer_load_dwordx4 v[68:71], v2, s[8:11], s48 offen offset:128 nt
  buffer_load_dwordx4 v[72:75], v2, s[8:11], s48 offen offset:256 nt
  s_nop 0
  v_mfma_f32_16x16x32_bf16 v[22:25], v[18:21], v[100:103], v[22:25]
  v_mfma_f32_16x16x32_bf16 v[26:29], v[18:21], v[104:107], v[26:29]
  v_mfma_f32_16x16x32_bf16 v[30:33], v[18:21], v[108:111], v[30:33]
  s_waitcnt lgkmcnt(0)
  v_and_b32 v14, v46, v6
  v_and_b32 v15, v46, v7
  v_and_b32 v16, v46, v8
  v_and_b32 v17, v46, v9
  s_lshr_b32 s46, s42, 1
  s_lshl_b32 s46, s46, 4
  s_and_b32 s47, s42, 1
  s_add_u32 s48, s46, s47
  s_add_u32 s48, s48, s43
  s_and_b32 s48, s48, 511
  s_mul_i32 s48, s48, 3072
  s_add_u32 s42, s42, 1
  s_and_b32 s42, s42, 63
  s_waitcnt vmcnt(0)
  buffer_load_dwordx4 v[76:79], v2, s[8:11], s48 offen offset:0 nt
  buffer_load_dwordx4 v[80:83], v2, s[8:11], s48 offen offset:128 nt
  buffer_load_dwordx4 v[84:87], v2, s[8:11], s48 offen offset:256 nt
  s_lshr_b32 s46, s42, 1
  s_lshl_b32 s46, s46, 4
  s_and_b32 s47, s42, 1
  s_add_u32 s48, s46, s47
  s_add_u32 s48, s48, s43
  s_and_b32 s48, s48, 511
  s_mul_i32 s48, s48, 3072
  s_add_u32 s42, s42, 1
  s_and_b32 s42, s42, 63
  buffer_load_dwordx4 v[88:91], v2, s[8:11], s48 offen offset:0 nt
  buffer_load_dwordx4 v[92:95], v2, s[8:11], s48 offen offset:128 nt
  buffer_load_dwordx4 v[96:99], v2, s[8:11], s48 offen offset:256 nt
  s_lshr_b32 s46, s42, 1
  s_lshl_b32 s46, s46, 4
  s_and_b32 s47, s42, 1
  s_add_u32 s48, s46, s47
  s_add_u32 s48, s48, s43
  s_and_b32 s48, s48, 511
  s_mul_i32 s48, s48, 3072
  s_add_u32 s42, s42, 1
  s_and_b32 s42, s42, 63
  buffer_load_dwordx4 v[100:103], v2, s[8:11], s48 offen offset:0 nt
  buffer_load_dwordx4 v[104:107], v2, s[8:11], s48 offen offset:128 nt
  buffer_load_dwordx4 v[108:111], v2, s[8:11], s48 offen offset:256 nt
  s_nop 0
  v_mfma_f32_16x16x32_bf16 v[22:25], v[14:17], v[64:67], v[22:25]
  v_mfma_f32_16x16x32_bf16 v[26:29], v[14:17], v[68:71], v[26:29]
  v_mfma_f32_16x16x32_bf16 v[30:33], v[14:17], v[72:75], v[30:33]
  v_and_b32 v18, v47, v6
  v_and_b32 v19, v47, v7
  v_and_b32 v20, v47, v8
  v_and_b32 v21, v47, v9
  s_lshr_b32 s46, s42, 1
  s_lshl_b32 s46, s46, 4
  s_and_b32 s47, s42, 1
  s_add_u32 s48, s46, s47
  s_add_u32 s48, s48, s43
  s_and_b32 s48, s48, 511
  s_mul_i32 s48, s48, 3072
  s_add_u32 s42, s42, 1
  s_and_b32 s42, s42, 63
  s_waitcnt vmcnt(6)
  buffer_load_dwordx4 v[64:67], v2, s[8:11], s48 offen offset:0 nt
  buffer_load_dwordx4 v[68:71], v2, s[8:11], s48 offen offset:128 nt
  buffer_load_dwordx4 v[72:75], v2, s[8:11], s48 offen offset:256 nt
  s_nop 0
  v_mfma_f32_16x16x32_bf16 v[22:25], v[18:21], v[76:79], v[22:25]
  v_mfma_f32_16x16x32_bf16 v[26:29], v[18:21], v[80:83], v[26:29]
  v_mfma_f32_16x16x32_bf16 v[30:33], v[18:21], v[84:87], v[30:33]
  v_and_b32 v14, v48, v6
  v_and_b32 v15, v48, v7
  v_and_b32 v16, v48, v8
  v_and_b32 v17, v48, v9
  s_lshr_b32 s46, s42, 1
  s_lshl_b32 s46, s46, 4
  s_and_b32 s47, s42, 1
  s_add_u32 s48, s46, s47
  s_add_u32 s48, s48, s43
  s_and_b32 s48, s48, 511
  s_mul_i32 s48, s48, 3072
  s_add_u32 s42, s42, 1
  s_and_b32 s42, s42, 63
  s_waitcnt vmcnt(6)
  buffer_load_dwordx4 v[76:79], v2, s[8:11], s48 offen offset:0 nt
  buffer_load_dwordx4 v[80:83], v2, s[8:11], s48 offen offset:128 nt
  buffer_load_dwordx4 v[84:87], v2, s[8:11], s48 offen offset:256 nt
  s_nop 0
  v_mfma_f32_16x16x32_bf16 v[22:25], v[14:17], v[88:91], v[22:25]
  v_mfma_f32_16x16x32_bf16 v[26:29], v[14:17], v[92:95], v[26:29]
  v_mfma_f32_16x16x32_bf16 v[30:33], v[14:17], v[96:99], v[30:33]
  v_and_b32 v18, v49, v6
  v_and_b32 v19, v49, v7
  v_and_b32 v20, v49, v8
  v_and_b32 v21, v49, v9
  s_lshr_b32 s46, s42, 1
  s_lshl_b32 s46, s46, 4
  s_and_b32 s47, s42, 1
  s_add_u32 s48, s46, s47
  s_add_u32 s48, s48, s43
  s_and_b32 s48, s48, 511
  s_mul_i32 s48, s48, 3072
  s_add_u32 s42, s42, 1
  s_and_b32 s42, s42, 63
  s_waitcnt vmcnt(6)
  buffer_load_dwordx4 v[88:91], v2, s[8:11], s48 offen offset:0 nt
  buffer_load_dwordx4 v[92:95], v2, s[8:11], s48 offen offset:128 nt
  buffer_load_dwordx4 v[96:99], v2, s[8:11], s48 offen offset:256 nt
  s_nop 0
  v_mfma_f32_16x16x32_bf16 v[22:25], v[18:21], v[100:103], v[22:25]
  v_mfma_f32_16x16x32_bf16 v[26:29], v[18:21], v[104:107], v[26:29]
  v_mfma_f32_16x16x32_bf16 v[30:33], v[18:21], v[108:111], v[30:33]
  v_and_b32 v14, v50, v6
  v_and_b32 v15, v50, v7
  v_and_b32 v16, v50, v8
  v_and_b32 v17, v50, v9
  s_lshr_b32 s46, s42, 1
  s_lshl_b32 s46, s46, 4
  s_and_b32 s47, s42, 1
  s_add_u32 s48, s46, s47
  s_add_u32 s48, s48, s43
  s_and_b32 s48, s48, 511
  s_mul_i32 s48, s48, 3072
  s_add_u32 s42, s42, 1
  s_and_b32 s42, s42, 63
  s_waitcnt vmcnt(6)
  buffer_load_dwordx4 v[100:103], v2, s[8:11], s48 offen offset:0 nt
  buffer_load_dwordx4 v[104:107], v2, s[8:11], s48 offen offset:128 nt
  buffer_load_dwordx4 v[108:111], v2, s[8:11], s48 offen offset:256 nt
  s_nop 0
  v_mfma_f32_16x16x32_bf16 v[22:25], v[14:17], v[64:67], v[22:25]
  v_mfma_f32_16x16x32_bf16 v[26:29], v[14:17], v[68:71], v[26:29]
  v_mfma_f32_16x16x32_bf16 v[30:33], v[14:17], v[72:75], v[30:33]
  v_and_b32 v18, v51, v6
  v_and_b32 v19, v51, v7
  v_and_b32 v20, v51, v8
  v_and_b32 v21, v51, v9
  s_waitcnt vmcnt(6)
  s_nop 0
  v_mfma_f32_16x16x32_bf16 v[22:25], v[18:21], v[76:79], v[22:25]
  v_mfma_f32_16x16x32_bf16 v[26:29], v[18:21], v[80:83], v[26:29]
  v_mfma_f32_16x16x32_bf16 v[30:33], v[18:21], v[84:87], v[30:33]
  v_and_b32 v14, v52, v6
  v_and_b32 v15, v52, v7
  v_and_b32 v16, v52, v8
  v_and_b32 v17, v52, v9
  s_waitcnt vmcnt(3)
  s_nop 0
  v_mfma_f32_16x16x32_bf16 v[22:25], v[14:17], v[88:91], v[22:25]
  v_mfma_f32_16x16x32_bf16 v[26:29], v[14:17], v[92:95], v[26:29]
  v_mfma_f32_16x16x32_bf16 v[30:33], v[14:17], v[96:99], v[30:33]
  v_and_b32 v18, v53, v6
  v_and_b32 v19, v53, v7
  v_and_b32 v20, v53, v8
  v_and_b32 v21, v53, v9
  s_waitcnt vmcnt(0)
  s_nop 0
  v_mfma_f32_16x16x32_bf16 v[22:25], v[18:21], v[100:103], v[22:25]
  v_mfma_f32_16x16x32_bf16 v[26:29], v[18:21], v[104:107], v[26:29]
  v_mfma_f32_16x16x32_bf16 v[30:33], v[18:21], v[108:111], v[30:33]
  v_lshrrev_b32 v58, 5, v1
  s_lshl_b32 s44, s3, 1
  v_add_u32 v58, s44, v58
  v_mul_u32_u24 v58, 768, v58
  v_and_b32 v59, 7, v1
  v_lshlrev_b32 v59, 5, v59
  v_add_u32 v58, v58, v59
  v_and_b32 v59, 16, v1
  v_add_u32 v58, v58, v59
  v_add_u32 v58, 56576, v58
  s_mov_b32 exec_lo, 0x00ff00ff
  s_mov_b32 exec_hi, 0xff00ff00
  ds_write_b128 v58, v[22:25] offset:0
  ds_write_b128 v58, v[26:29] offset:256
  ds_write_b128 v58, v[30:33] offset:512
  s_mov_b64 exec, -1
  s_waitcnt lgkmcnt(0)
  s_barrier
  s_cmp_ge_u32 s3, 3
  s_cbranch_scc1 recurrent_scan__mha_block_cached__dense_activation_squared_relu__decode_kernel_t2_ffn
  v_mov_b32 v58, 19584
  ds_read_b128 v[64:67], v58 offset:0
  ds_read_b128 v[68:71], v58 offset:16
  ds_read_b128 v[72:75], v58 offset:32
  ds_read_b128 v[76:79], v58 offset:48
  v_lshlrev_b32 v59, 2, v0
  v_add_u32 v59, 56576, v59
  ds_read2st64_b32 v[80:81], v59 offset0:0 offset1:3
  ds_read2st64_b32 v[82:83], v59 offset0:6 offset1:9
  ds_read2st64_b32 v[84:85], v59 offset0:12 offset1:15
  ds_read2st64_b32 v[86:87], v59 offset0:18 offset1:21
  ds_read2st64_b32 v[88:89], v59 offset0:24 offset1:27
  ds_read2st64_b32 v[90:91], v59 offset0:30 offset1:33
  ds_read2st64_b32 v[92:93], v59 offset0:36 offset1:39
  ds_read2st64_b32 v[94:95], v59 offset0:42 offset1:45
  s_waitcnt lgkmcnt(8)
  v_max3_f32 v60, v64, v66, v68
  v_max3_f32 v60, v60, v70, v72
  v_max3_f32 v60, v60, v74, v76
  v_max_f32 v60, v60, v78
  v_sub_f32 v64, v64, v60
  v_sub_f32 v66, v66, v60
  v_sub_f32 v68, v68, v60
  v_sub_f32 v70, v70, v60
  v_sub_f32 v72, v72, v60
  v_sub_f32 v74, v74, v60
  v_sub_f32 v76, v76, v60
  v_sub_f32 v78, v78, v60
  v_mul_f32 v64, 0x3fb8aa3b, v64
  v_mul_f32 v66, 0x3fb8aa3b, v66
  v_mul_f32 v68, 0x3fb8aa3b, v68
  v_mul_f32 v70, 0x3fb8aa3b, v70
  v_mul_f32 v72, 0x3fb8aa3b, v72
  v_mul_f32 v74, 0x3fb8aa3b, v74
  v_mul_f32 v76, 0x3fb8aa3b, v76
  v_mul_f32 v78, 0x3fb8aa3b, v78
  v_exp_f32 v64, v64
  v_exp_f32 v66, v66
  v_exp_f32 v68, v68
  v_exp_f32 v70, v70
  v_exp_f32 v72, v72
  v_exp_f32 v74, v74
  v_exp_f32 v76, v76
  v_exp_f32 v78, v78
  s_nop 0
  v_mul_f32 v61, v64, v65
  v_fmac_f32 v61, v66, v67
  v_fmac_f32 v61, v68, v69
  v_fmac_f32 v61, v70, v71
  v_fmac_f32 v61, v72, v73
  v_fmac_f32 v61, v74, v75
  v_fmac_f32 v61, v76, v77
  v_fmac_f32 v61, v78, v79
  v_rcp_f32 v62, v61
  s_waitcnt lgkmcnt(0)
  v_add_f32 v80, v80, v81
  v_add_f32 v82, v82, v83
  v_add_f32 v84, v84, v85
  v_add_f32 v86, v86, v87
  v_add_f32 v88, v88, v89
  v_add_f32 v90, v90, v91
  v_add_f32 v92, v92, v93
  v_add_f32 v94, v94, v95
  v_mul_f32 v63, v80, v64
  v_fmac_f32 v63, v82, v66
  v_fmac_f32 v63, v84, v68
  v_fmac_f32 v63, v86, v70
  v_fmac_f32 v63, v88, v72
  v_fmac_f32 v63, v90, v74
  v_fmac_f32 v63, v92, v76
  v_fmac_f32 v63, v94, v78
  v_mul_f32 v58, v63, v62
  v_fma_f32 v59, -v58, v61, v63
  v_fma_f32 v58, v59, v62, v58
  v_cvt_pk_bf16_f32 v58, v58, v58
  v_lshlrev_b32 v59, 2, v0
  v_add_u32 v59, 68864, v59
  ds_write_b32 v59, v58
  s_waitcnt lgkmcnt(0)
  s_branch recurrent_scan__mha_block_cached__dense_activation_squared_relu__decode_kernel_t2_done
recurrent_scan__mha_block_cached__dense_activation_squared_relu__decode_kernel_t2_ffn:
  s_cmp_eq_u32 s3, 3
  s_cbranch_scc1 recurrent_scan__mha_block_cached__dense_activation_squared_relu__decode_kernel_t2_done
  s_cmp_eq_u32 s3, 7
  s_cbranch_scc1 recurrent_scan__mha_block_cached__dense_activation_squared_relu__decode_kernel_t2_done
  s_cmp_ge_u32 s41, 24
  s_cbranch_scc1 recurrent_scan__mha_block_cached__dense_activation_squared_relu__decode_kernel_t2_done
  v_subrev_u32 v58, 256, v0
  v_cmp_gt_u32 vcc, 160, v58
  v_lshlrev_b32 v59, 4, v58
  s_and_saveexec_b64 s[44:45], vcc
  ds_read_b128 v[64:67], v59 offset:36096
  ds_read_b128 v[68:71], v59 offset:38656
  ds_read_b128 v[72:75], v59 offset:41216
  ds_read_b128 v[76:79], v59 offset:43776
  ds_read_b128 v[80:83], v59 offset:46336
  ds_read_b128 v[84:87], v59 offset:48896
  ds_read_b128 v[88:91], v59 offset:51456
  ds_read_b128 v[92:95], v59 offset:54016
  s_waitcnt lgkmcnt(0)
  v_add_f32 v64, v64, v68
  v_add_f32 v65, v65, v69
  v_add_f32 v66, v66, v70
  v_add_f32 v67, v67, v71
  v_add_f32 v72, v72, v76
  v_add_f32 v73, v73, v77
  v_add_f32 v74, v74, v78
  v_add_f32 v75, v75, v79
  v_add_f32 v80, v80, v84
  v_add_f32 v81, v81, v85
  v_add_f32 v82, v82, v86
  v_add_f32 v83, v83, v87
  v_add_f32 v88, v88, v92
  v_add_f32 v89, v89, v93
  v_add_f32 v90, v90, v94
  v_add_f32 v91, v91, v95
  v_add_f32 v64, v64, v72
  v_add_f32 v65, v65, v73
  v_add_f32 v66, v66, v74
  v_add_f32 v67, v67, v75
  v_add_f32 v80, v80, v88
  v_add_f32 v81, v81, v89
  v_add_f32 v82, v82, v90
  v_add_f32 v83, v83, v91
  v_add_f32 v64, v64, v80
  v_add_f32 v65, v65, v81
  v_add_f32 v66, v66, v82
  v_add_f32 v67, v67, v83
  s_lshl_b32 s46, s40, 5
  s_add_u32 s46, s46, s41
  s_mul_i32 s46, s46, 2560
  s_add_u32 s46, s46, 655360
  buffer_store_dwordx4 v[64:67], v59, s[36:39], s46 offen
  s_mov_b64 exec, s[44:45]
recurrent_scan__mha_block_cached__dense_activation_squared_relu__decode_kernel_t2_done:
  s_barrier
  v_lshrrev_b32 v58, 4, v1
  v_lshlrev_b32 v58, 2, v58
  s_mul_i32 s44, s3, 96
  s_add_u32 s44, s44, 68864
  v_add_u32 v58, s44, v58
  ds_read_b32 v38, v58 offset:0
  ds_read_b32 v39, v58 offset:16
  ds_read_b32 v40, v58 offset:32
  ds_read_b32 v41, v58 offset:48
  ds_read_b32 v42, v58 offset:64
  ds_read_b32 v43, v58 offset:80
  s_waitcnt lgkmcnt(5)
  v_and_b32 v14, v38, v10
  v_and_b32 v15, v38, v11
  v_and_b32 v16, v38, v12
  v_and_b32 v17, v38, v13
  s_nop 1
  v_mfma_f32_16x16x32_bf16 v[232:235], v[14:17], v[112:115], 0
  v_mfma_f32_16x16x32_bf16 v[236:239], v[14:17], v[116:119], 0
  v_mfma_f32_16x16x32_bf16 v[240:243], v[14:17], v[120:123], 0
  v_mfma_f32_16x16x32_bf16 v[244:247], v[14:17], v[124:127], 0
  v_mfma_f32_16x16x32_bf16 v[248:251], v[14:17], v[128:131], 0
  s_waitcnt lgkmcnt(4)
  v_and_b32 v18, v39, v10
  v_and_b32 v19, v39, v11
  v_and_b32 v20, v39, v12
  v_and_b32 v21, v39, v13
  s_nop 1
  v_mfma_f32_16x16x32_bf16 v[232:235], v[18:21], v[132:135], v[232:235]
  v_mfma_f32_16x16x32_bf16 v[236:239], v[18:21], v[136:139], v[236:239]
  v_mfma_f32_16x16x32_bf16 v[240:243], v[18:21], v[140:143], v[240:243]
  v_mfma_f32_16x16x32_bf16 v[244:247], v[18:21], v[144:147], v[244:247]
  v_mfma_f32_16x16x32_bf16 v[248:251], v[18:21], v[148:151], v[248:251]
  s_waitcnt lgkmcnt(3)
  v_and_b32 v14, v40, v10
  v_and_b32 v15, v40, v11
  v_and_b32 v16, v40, v12
  v_and_b32 v17, v40, v13
  s_nop 1
  v_mfma_f32_16x16x32_bf16 v[232:235], v[14:17], v[152:155], v[232:235]
  v_mfma_f32_16x16x32_bf16 v[236:239], v[14:17], v[156:159], v[236:239]
  v_mfma_f32_16x16x32_bf16 v[240:243], v[14:17], v[160:163], v[240:243]
  v_mfma_f32_16x16x32_bf16 v[244:247], v[14:17], v[164:167], v[244:247]
  v_mfma_f32_16x16x32_bf16 v[248:251], v[14:17], v[168:171], v[248:251]
  s_waitcnt lgkmcnt(2)
  v_and_b32 v18, v41, v10
  v_and_b32 v19, v41, v11
  v_and_b32 v20, v41, v12
  v_and_b32 v21, v41, v13
  s_nop 1
  v_mfma_f32_16x16x32_bf16 v[232:235], v[18:21], v[172:175], v[232:235]
  v_mfma_f32_16x16x32_bf16 v[236:239], v[18:21], v[176:179], v[236:239]
  v_mfma_f32_16x16x32_bf16 v[240:243], v[18:21], v[180:183], v[240:243]
  v_mfma_f32_16x16x32_bf16 v[244:247], v[18:21], v[184:187], v[244:247]
  v_mfma_f32_16x16x32_bf16 v[248:251], v[18:21], v[188:191], v[248:251]
  s_waitcnt lgkmcnt(1)
  v_and_b32 v14, v42, v10
  v_and_b32 v15, v42, v11
  v_and_b32 v16, v42, v12
  v_and_b32 v17, v42, v13
  s_nop 1
  v_mfma_f32_16x16x32_bf16 v[232:235], v[14:17], v[192:195], v[232:235]
  v_mfma_f32_16x16x32_bf16 v[236:239], v[14:17], v[196:199], v[236:239]
  v_mfma_f32_16x16x32_bf16 v[240:243], v[14:17], v[200:203], v[240:243]
  v_mfma_f32_16x16x32_bf16 v[244:247], v[14:17], v[204:207], v[244:247]
  v_mfma_f32_16x16x32_bf16 v[248:251], v[14:17], v[208:211], v[248:251]
  s_waitcnt lgkmcnt(0)
  v_and_b32 v18, v43, v10
  v_and_b32 v19, v43, v11
  v_and_b32 v20, v43, v12
  v_and_b32 v21, v43, v13
  s_nop 1
  v_mfma_f32_16x16x32_bf16 v[232:235], v[18:21], v[212:215], v[232:235]
  v_mfma_f32_16x16x32_bf16 v[236:239], v[18:21], v[216:219], v[236:239]
  v_mfma_f32_16x16x32_bf16 v[240:243], v[18:21], v[220:223], v[240:243]
  v_mfma_f32_16x16x32_bf16 v[244:247], v[18:21], v[224:227], v[244:247]
  v_mfma_f32_16x16x32_bf16 v[248:251], v[18:21], v[228:231], v[248:251]
  v_and_b32 v62, 15, v1
  v_lshlrev_b32 v62, 5, v62
  v_and_b32 v63, 16, v1
  v_add_u32 v62, v62, v63
  s_mul_i32 s44, s3, 2560
  s_add_u32 s44, s44, 69632
  v_add_u32 v62, s44, v62
  s_nop 2
  s_mov_b32 exec_hi, 0
  ds_write_b128 v62, v[232:235] offset:0
  ds_write_b128 v62, v[236:239] offset:512
  ds_write_b128 v62, v[240:243] offset:1024
  ds_write_b128 v62, v[244:247] offset:1536
  ds_write_b128 v62, v[248:251] offset:2048
  s_mov_b64 exec, -1
  s_waitcnt lgkmcnt(0)
  s_barrier
  s_cmp_ge_u32 s3, 3
  s_cbranch_scc1 recurrent_scan__mha_block_cached__dense_activation_squared_relu__decode_kernel_endw
  v_cmp_gt_u32 vcc, 160, v0
  v_lshlrev_b32 v59, 4, v0
  v_add_u32 v60, 69632, v59
  s_and_saveexec_b64 s[44:45], vcc
  ds_read_b128 v[64:67], v60 offset:0
  ds_read_b128 v[68:71], v60 offset:2560
  ds_read_b128 v[72:75], v60 offset:5120
  ds_read_b128 v[76:79], v60 offset:7680
  ds_read_b128 v[80:83], v60 offset:10240
  ds_read_b128 v[84:87], v60 offset:12800
  ds_read_b128 v[88:91], v60 offset:15360
  ds_read_b128 v[92:95], v60 offset:17920
  s_waitcnt lgkmcnt(0)
  v_add_f32 v64, v64, v68
  v_add_f32 v65, v65, v69
  v_add_f32 v66, v66, v70
  v_add_f32 v67, v67, v71
  v_add_f32 v72, v72, v76
  v_add_f32 v73, v73, v77
  v_add_f32 v74, v74, v78
  v_add_f32 v75, v75, v79
  v_add_f32 v80, v80, v84
  v_add_f32 v81, v81, v85
  v_add_f32 v82, v82, v86
  v_add_f32 v83, v83, v87
  v_add_f32 v88, v88, v92
  v_add_f32 v89, v89, v93
  v_add_f32 v90, v90, v94
  v_add_f32 v91, v91, v95
  v_add_f32 v64, v64, v72
  v_add_f32 v65, v65, v73
  v_add_f32 v66, v66, v74
  v_add_f32 v67, v67, v75
  v_add_f32 v80, v80, v88
  v_add_f32 v81, v81, v89
  v_add_f32 v82, v82, v90
  v_add_f32 v83, v83, v91
  v_add_f32 v64, v64, v80
  v_add_f32 v65, v65, v81
  v_add_f32 v66, v66, v82
  v_add_f32 v67, v67, v83
  s_lshl_b32 s46, s40, 5
  s_add_u32 s46, s46, s41
  s_mul_i32 s46, s46, 2560
  buffer_store_dwordx4 v[64:67], v59, s[36:39], s46 offen
  s_mov_b64 exec, -1
recurrent_scan__mha_block_cached__dense_activation_squared_relu__decode_kernel_endw:
recurrent_scan__mha_block_cached__dense_activation_squared_relu__decode_kernel_end:
  s_endpgm
.section .rodata,"a"
.p2align 6
.amdhsa_kernel recurrent_scan__mha_block_cached__dense_activation_squared_relu__decode_kernel
  .amdhsa_next_free_vgpr 256
  .amdhsa_next_free_sgpr 102
  .amdhsa_accum_offset 256
  .amdhsa_group_segment_fixed_size 0
  .amdhsa_kernarg_size 104
  .amdhsa_user_sgpr_count 2
  .amdhsa_user_sgpr_kernarg_segment_ptr 1
  .amdhsa_system_sgpr_workgroup_id_x 1
.end_amdhsa_kernel

.text
.globl final_reduce_kernel
.p2align 8
.type final_reduce_kernel,@function
final_reduce_kernel:

  s_cmp_ge_u32 s2, 320
  s_cbranch_scc1 final_reduce_kernel_end
  s_load_dwordx2 s[4:5], s[0:1], 0
  s_load_dwordx4 s[8:11], s[0:1], 72
  s_load_dwordx2 s[12:13], s[0:1], 96
  s_mul_hi_u32 s14, s2, 0x6666667
  s_mul_i32 s15, s14, 40
  s_sub_u32 s15, s2, s15
  s_lshl_b32 s15, s15, 4
  v_and_b32 v1, 15, v0
  v_add_u32 v1, s15, v1
  v_lshrrev_b32 v8, 4, v0
  v_mul_u32_u24 v2, 20480, v8
  v_lshl_add_u32 v2, v1, 2, v2
  v_mul_u32_u24 v9, 15360, v8
  v_lshl_add_u32 v9, v1, 2, v9
  v_lshlrev_b32 v3, 1, v1
  s_waitcnt lgkmcnt(0)
  s_mul_i32 s16, s14, 81920
  s_add_u32 s20, s12, s16
  s_addc_u32 s21, s13, 0
  s_mov_b32 s22, 81920
  s_mov_b32 s23, 0x20000
  s_add_u32 s24, s20, 655360
  s_addc_u32 s25, s21, 0
  s_mov_b32 s26, 61440
  s_mov_b32 s27, 0x20000
  s_mov_b32 s17, 0
  buffer_load_dword v10, v2, s[20:23], s17 offen
  buffer_load_dword v26, v9, s[24:27], s17 offen
  s_add_u32 s17, s17, 2560
  buffer_load_dword v11, v2, s[20:23], s17 offen
  buffer_load_dword v27, v9, s[24:27], s17 offen
  s_add_u32 s17, s17, 2560
  buffer_load_dword v12, v2, s[20:23], s17 offen
  buffer_load_dword v28, v9, s[24:27], s17 offen
  s_add_u32 s17, s17, 2560
  buffer_load_dword v13, v2, s[20:23], s17 offen
  buffer_load_dword v29, v9, s[24:27], s17 offen
  s_add_u32 s17, s17, 2560
  buffer_load_dword v14, v2, s[20:23], s17 offen
  buffer_load_dword v30, v9, s[24:27], s17 offen
  s_add_u32 s17, s17, 2560
  buffer_load_dword v15, v2, s[20:23], s17 offen
  buffer_load_dword v31, v9, s[24:27], s17 offen
  s_add_u32 s17, s17, 2560
  buffer_load_dword v16, v2, s[20:23], s17 offen
  s_add_u32 s17, s17, 2560
  buffer_load_dword v17, v2, s[20:23], s17 offen
  s_mul_i32 s16, s14, 1280
  s_add_u32 s28, s4, s16
  s_addc_u32 s29, s5, 0
  s_mov_b32 s30, 1280
  s_mov_b32 s31, 0x20000
  s_mov_b32 s32, s8
  s_mov_b32 s33, s9
  s_mov_b32 s34, 1280
  s_mov_b32 s35, 0x20000
  s_add_u32 s36, s10, s16
  s_addc_u32 s37, s11, 0
  s_mov_b32 s38, 1280
  s_mov_b32 s39, 0x20000
  buffer_load_ushort v4, v3, s[28:31], 0 offen
  buffer_load_ushort v5, v3, s[32:35], 0 offen
  s_waitcnt vmcnt(2)
  v_add_f32 v10, v10, v11
  v_add_f32 v12, v12, v13
  v_add_f32 v14, v14, v15
  v_add_f32 v16, v16, v17
  v_add_f32 v10, v10, v12
  v_add_f32 v14, v14, v16
  v_add_f32 v10, v10, v14
  v_add_f32 v26, v26, v27
  v_add_f32 v28, v28, v29
  v_add_f32 v30, v30, v31
  v_add_f32 v26, v26, v28
  v_add_f32 v26, v26, v30
  v_mov_b32 v24, v10
  v_mov_b32 v25, v26
  s_nop 0
  v_permlane16_swap_b32 v10, v24
  v_permlane16_swap_b32 v26, v25
  s_nop 0
  v_add_f32 v10, v10, v24
  v_add_f32 v26, v26, v25
  v_mov_b32 v24, v10
  v_mov_b32 v25, v26
  s_nop 0
  v_permlane32_swap_b32 v10, v24
  v_permlane32_swap_b32 v26, v25
  s_nop 0
  v_add_f32 v10, v10, v24
  v_add_f32 v26, v26, v25
  v_cvt_pk_bf16_f32 v10, v10, v10
  v_and_b32 v10, 0xffff0000, v10
  v_cvt_pk_bf16_f32 v26, v26, v26
  v_and_b32 v26, 0xffff0000, v26
  s_waitcnt vmcnt(0)
  v_lshlrev_b32 v5, 16, v5
  v_lshlrev_b32 v4, 16, v4
  v_add_f32 v26, v26, v5
  v_cvt_pk_bf16_f32 v26, v26, v26
  v_and_b32 v26, 0xffff0000, v26
  v_mul_f32 v6, 0xbfb8aa3b, v26
  v_exp_f32 v6, v6
  s_nop 0
  v_add_f32 v6, 1.0, v6
  v_rcp_f32 v7, v6
  s_nop 0
  v_mul_f32 v6, v26, v7
  v_cvt_pk_bf16_f32 v6, v6, v6
  v_and_b32 v6, 0xffff0000, v6
  v_mul_f32 v6, v10, v6
  v_cvt_pk_bf16_f32 v6, v6, v6
  v_and_b32 v6, 0xffff0000, v6
  v_add_f32 v6, v4, v6
  v_cvt_pk_bf16_f32 v6, v6, v6
  s_mov_b32 exec_lo, 0xffff
  s_mov_b32 exec_hi, 0
  buffer_store_short v6, v3, s[36:39], 0 offen
final_reduce_kernel_end:
  s_endpgm
.section .rodata,"a"
.p2align 6
.amdhsa_kernel final_reduce_kernel
  .amdhsa_next_free_vgpr 40
  .amdhsa_next_free_sgpr 102
  .amdhsa_accum_offset 40
  .amdhsa_group_segment_fixed_size 0
  .amdhsa_kernarg_size 104
  .amdhsa_user_sgpr_count 2
  .amdhsa_user_sgpr_kernarg_segment_ptr 1
  .amdhsa_system_sgpr_workgroup_id_x 1
.end_amdhsa_kernel
```
